```python
import torch

def _softmax(x, axis=-1):
    return torch.softmax(x, dim=axis)
def _gelu(x):
    return torch.nn.functional.gelu(x, approximate="tanh")
def _silu(x):
    return torch.nn.functional.silu(x)
def _sigmoid(x):
    return torch.sigmoid(x)
def _layernorm(x, axis=-1, eps=1e-5):
    m = x.mean(dim=axis, keepdim=True)
    v = x.var(dim=axis, keepdim=True, unbiased=False)
    return (x - m) / torch.sqrt(v + eps)
def _scatter_add(tgt, idx, src, axis=0):
    return tgt.clone().index_add_(axis, idx, src)
def _segment_sum(src, seg, n):
    out = torch.zeros((n,) + src.shape[1:], dtype=src.dtype)
    return out.index_add_(0, seg, src)
def _pad(x, pw):
    flat = tuple(v for pair in reversed(pw) for v in pair)
    return torch.nn.functional.pad(x, flat)

kernel_name = 'standalone__gqa_block_cached__near_ridge'

def setup_inputs():

    _w = (lambda a: (lambda t: t.to(torch.bfloat16) if t.is_floating_point() else t)(torch.as_tensor(a)))
    B, Sq, D = 16, 64, 576
    Hq, Hkv, Sk, Dh = 32, 16, 512, 128
    assert Hq % Hkv == 0, (Hq, Hkv)
    return {
        "x": _w((lambda *s: torch.randn(*s, dtype=torch.bfloat16) * 0.8)(B, Sq, D)),
        "k_cache": _w((lambda *s: torch.randn(*s, dtype=torch.bfloat16) * 0.8)(B, Hkv, Sk, Dh)),
        "v_cache": _w((lambda *s: torch.randn(*s, dtype=torch.bfloat16) * 0.05)(B, Hkv, Sk, Dh)),
        "wq": _w((lambda *s: torch.randn(*s, dtype=torch.bfloat16) * 0.8)(D, Hq * Dh) * (D ** -0.5)),
        "wo": _w((lambda *s: torch.randn(*s, dtype=torch.bfloat16) * 0.05)(Hq * Dh, D) * ((Hq * Dh) ** -0.5)),
    }

def reference(x, k_cache, v_cache, wq, wo):
    B, Sq, D = x.shape
    Hq, Dh = 32, 128
    Hkv = k_cache.shape[1]
    rep = Hq // Hkv
    q = (lambda x, *d: x.permute(*d))((x @ wq).reshape(B, Sq, Hq, Dh), 0, 2, 1, 3)
    k = (lambda x, n, axis: torch.repeat_interleave(x, n, dim=axis))(k_cache, rep, axis=1)
    v = (lambda x, n, axis: torch.repeat_interleave(x, n, dim=axis))(v_cache, rep, axis=1)
    scores = torch.einsum("bhqd,bhkd->bhqk", q, k) * (Dh ** -0.5)
    p = _softmax(scores, axis=-1)
    o = torch.einsum("bhqk,bhkd->bhqd", p, v)
    return (lambda x, *d: x.permute(*d))(o, 0, 2, 1, 3).reshape(B, Sq, Hq * Dh) @ wo
```

```asm
; @launch grid=(256,1,1) block=(512,1,1) lds=163840
.amdgcn_target "amdgcn-amd-amdhsa--gfx950"
.text
.globl standalone__gqa_block_cached__near_ridge_kernel
.p2align 8
.type standalone__gqa_block_cached__near_ridge_kernel,@function
standalone__gqa_block_cached__near_ridge_kernel:
    s_load_dwordx2 s[8:9], s[0:1], 0
    s_load_dwordx2 s[20:21], s[0:1], 24
    s_load_dwordx2 s[28:29], s[0:1], 56
    s_load_dwordx2 s[12:13], s[0:1], 8
    s_load_dwordx2 s[16:17], s[0:1], 16
    s_load_dwordx2 s[24:25], s[0:1], 32
    s_load_dwordx2 s[32:33], s[0:1], 40
    s_cmp_ge_u32 s2, 256
    s_cbranch_scc1 L_end
    v_lshrrev_b32 v4, 6, v0
    v_and_b32 v1, 63, v0
    v_readfirstlane_b32 s3, v4
    s_lshr_b32 s4, s2, 4
    s_and_b32 s5, s2, 7
    s_mov_b32 s10, 1179648
    s_mov_b32 s11, 0x20000
    s_mov_b32 s22, 4718592
    s_mov_b32 s23, s11
    s_bfe_u32 s60, s2, 0x10003
    s_and_b32 s61, s3, 6
    s_cmp_eq_u32 s61, 4
    s_cbranch_scc1 L_ft2
    s_cmp_ge_u32 s3, 6
    s_cselect_b32 s65, 2, 0
    s_sub_u32 s65, s3, s65
    s_getpc_b64 s[62:63]
    s_lshr_b32 s61, s2, 3
    s_mul_i32 s61, s61, 6
    s_add_u32 s61, s61, s65
    s_add_u32 s61, s61, 6
    s_min_u32 s61, s61, 196
    s_lshl_b32 s61, s61, 7
    s_add_u32 s62, s62, s61
    s_addc_u32 s63, s63, 0
    v_mov_b32 v6, s62
    v_mov_b32 v7, s63
    global_load_dword v255, v[6:7], off
    v_mul_u32_u24 v8, 1152, v1
    v_lshrrev_b32 v9, 5, v1
    v_lshlrev_b32 v9, 19, v9
    v_bfe_u32 v10, v1, 3, 2
    v_lshl_add_u32 v9, v10, 13, v9
    v_and_b32 v10, 7, v1
    v_lshl_add_u32 v9, v10, 7, v9
    v_lshl_add_u32 v9, s65, 20, v9
    s_mul_i32 s61, s60, 3
    s_add_u32 s62, s61, s65
    s_lshl_b32 s62, s62, 7
    s_mul_i32 s63, s4, 73728
    s_add_u32 s62, s62, s63
    s_lshl_b32 s63, s4, 5
    s_add_u32 s63, s63, s5
    s_lshl_b32 s63, s63, 10
    s_mul_i32 s61, s60, 3
    s_add_u32 s61, s61, 3
    s_mul_i32 s64, s60, 5
    s_waitcnt lgkmcnt(0)
    s_cmp_ge_u32 s65, s64
    s_cbranch_scc1 L_ft1
    buffer_load_dword v254, v9, s[20:23], s63 offen
L_ft1:
    s_cmp_ge_u32 s65, s61
    s_cbranch_scc1 L_ft2
    buffer_load_dword v253, v8, s[8:11], s62 offen
L_ft2:
    s_lshl1_add_u32 s5, s5, s60
    s_mul_i32 s7, s4, 9
    s_lshr_b32 s7, s7, 4
    s_mov_b32 s30, 0x10000000
    s_mov_b32 s31, s11
    s_mov_b32 s34, s10
    s_mov_b32 s35, s11
    s_mov_b32 s100, 0
    s_cmp_lt_u32 s3, 4
    s_cbranch_scc1 L_comp
    s_cmp_gt_u32 s3, 5
    s_cbranch_scc1 L_helper
    s_sub_u32 s72, s3, 4
    s_setprio 3
    v_lshlrev_b32 v34, 2, v1
    v_mul_u32_u24 v36, 17408, v1
    v_add_u32 v36, 7169, v36
    s_lshl1_add_u32 s47, s2, s72
    s_lshl_b32 s47, s47, 8
    s_add_u32 s47, s47, 41943040
    s_waitcnt lgkmcnt(0)
    buffer_store_dword v36, v34, s[28:31], s47 offen
    s_load_dwordx2 s[36:37], s[0:1], 48
    s_mov_b32 s38, 256
    s_mov_b32 s39, s11
    v_mov_b32 v29, 0
    v_lshrrev_b32 v30, 3, v1
    v_and_b32 v31, 7, v1
    v_lshrrev_b32 v32, 4, v1
    v_and_b32 v37, 1, v32
    v_lshlrev_b32 v37, 2, v37
    v_xor_b32 v37, v37, v31
    v_lshlrev_b32 v37, 4, v37
    v_lshl_add_u32 v16, v30, 13, v37
    v_add_u32 v19, 0, v16
    v_add_u32 v18, 896, v16
    v_add_u32 v17, 1792, v16
    v_add_u32 v16, 2688, v16
    s_mov_b64 s[26:27], s[22:23]
    s_sub_u32 s20, s20, 2688
    s_subb_u32 s21, s21, 0
    s_add_u32 s22, s22, 2688
    v_mul_u32_u24 v33, 1152, v30
    v_xor_b32 v35, v31, v32
    v_lshl_add_u32 v24, v35, 4, v33
    v_xor_b32 v25, 64, v24
    v_add_u32 v25, 8192, v25
    v_add_u32 v26, 16384, v24
    v_add_u32 v27, 16384, v25
    s_mov_b32 s67, 0
    s_xor_b32 s57, s72, 1
    s_mov_b32 s68, 0
    s_sub_u32 s12, s12, 192
    s_subb_u32 s13, s13, 0
    s_mov_b32 s14, 33554624
    s_mov_b32 s15, s11
    s_mov_b32 s18, 0x2000000
    s_mov_b32 s19, s11
    s_lshl_b32 s81, s72, 12
    s_add_u32 s81, s81, 3072
    s_lshl1_add_u32 s83, s4, s72
    s_mul_i32 s83, s83, 36864
    s_mov_b32 s82, 0
    s_mov_b32 s69, 1
    s_cmp_eq_u32 s72, 0
    s_cbranch_scc1 L_x
L_wq:
    s_add_u32 s41, s57, 4
    s_mov_b32 s66, 0
    s_sub_u32 s60, s57, 1
    s_sub_u32 s61, s57, 3
    s_cmp_ge_u32 s57, 5
    s_cselect_b32 s41, s60, s41
    s_cselect_b32 s66, s61, s66
    s_sub_u32 s61, s57, 6
    s_max_i32 s61, s61, 6
    s_min_i32 s61, s61, 10
    s_sub_u32 s60, s57, 9
    s_cmp_ge_u32 s57, 9
    s_cselect_b32 s41, s60, s41
    s_cselect_b32 s66, s61, s66
    s_mul_i32 s64, s41, 17408
    s_add_u32 s64, s64, 7168
    s_lshl_b32 s59, s57, 9
    s_add_u32 s59, s59, s5
    s_lshl_b32 s59, s59, 9
    s_lshl2_add_u32 s65, s57, 1040
L_req:
    s_cmp_ge_i32 s67, s66
    s_cbranch_scc0 L_chkq
    s_mov_b32 m0, s64
    s_nop 0
    buffer_load_dwordx4 v16, s[20:23], s59 offen offset:0 lds
    buffer_load_dwordx4 v17, s[20:23], s59 offen offset:1024 lds
    buffer_load_dwordx4 v18, s[20:23], s59 offen offset:2048 lds
    buffer_load_dwordx4 v19, s[20:23], s59 offen offset:3072 lds
    s_add_u32 m0, s64, 4096
    s_add_u32 s59, s59, 65536
    buffer_load_dwordx4 v16, s[20:23], s59 offen offset:0 lds
    buffer_load_dwordx4 v17, s[20:23], s59 offen offset:1024 lds
    buffer_load_dwordx4 v18, s[20:23], s59 offen offset:2048 lds
    buffer_load_dwordx4 v19, s[20:23], s59 offen offset:3072 lds
    s_add_u32 m0, s64, 8192
    s_add_u32 s59, s59, 65536
    buffer_load_dwordx4 v16, s[20:23], s59 offen offset:0 lds
    buffer_load_dwordx4 v17, s[20:23], s59 offen offset:1024 lds
    buffer_load_dwordx4 v18, s[20:23], s59 offen offset:2048 lds
    buffer_load_dwordx4 v19, s[20:23], s59 offen offset:3072 lds
    s_add_u32 m0, s64, 12288
    s_add_u32 s59, s59, 65536
    buffer_load_dwordx4 v16, s[20:23], s59 offen offset:0 lds
    buffer_load_dwordx4 v17, s[20:23], s59 offen offset:1024 lds
    buffer_load_dwordx4 v18, s[20:23], s59 offen offset:2048 lds
    buffer_load_dwordx4 v19, s[20:23], s59 offen offset:3072 lds
    s_cmp_eq_u32 s68, 0
    s_cbranch_scc1 L_wq3
    s_mov_b32 m0, s65
    s_lshl2_add_u32 s60, s41, s47
    s_mov_b64 exec, 1
    buffer_load_dword v29, s[28:31], s60 offen lds
    s_mov_b64 exec, -1
L_wq3:
    s_add_u32 s57, s57, 2
    s_cmp_lt_u32 s57, s69
    s_cbranch_scc1 L_wq
    s_cmp_eq_u32 s68, 3
    s_cbranch_scc1 L_kv0
    s_cmp_eq_u32 s68, 2
    s_cbranch_scc1 L_x3
L_x:
    s_cmp_eq_u32 s68, 0
    s_mov_b32 s61, 76800
    s_cselect_b32 s61, 27648, s61
    s_mov_b32 s64, s81
L_xl:
    s_add_u32 s59, s83, s82
    s_mov_b32 m0, s64
    s_nop 0
    buffer_load_dwordx4 v24, s[8:11], s59 offen offset:0 lds
    buffer_load_dwordx4 v25, s[8:11], s59 offen offset:1024 lds
    buffer_load_dwordx4 v26, s[8:11], s59 offen offset:2048 lds
    buffer_load_dwordx4 v27, s[8:11], s59 offen offset:3072 lds
    s_add_u32 s64, s64, 8192
    s_add_u32 s82, s82, 128
    s_cmp_lt_u32 s64, s61
    s_cbranch_scc1 L_xl
    s_mov_b32 s81, s64
    s_cmp_lg_u32 s68, 0
    s_cbranch_scc1 L_x2
    s_lshl_b32 s98, s4, 4
    s_add_u32 s98, s98, s5
    s_lshl_b32 s98, s98, 17
    s_add_u32 s79, s4, s5
    s_and_b32 s79, s79, 7
    s_lshl_b32 s79, s79, 14
    s_mov_b32 s80, s79
    s_mov_b32 s58, 0
    s_mov_b32 s45, 0
    s_mov_b32 s74, 2454316820
    s_mov_b32 s75, 600228
    s_cmp_eq_u32 s72, 0
    s_cbranch_scc1 L_x1a
    s_waitcnt vmcnt(28)
    s_barrier
    s_mov_b32 m0, s65
    s_lshl2_add_u32 s60, s41, s47
    s_mov_b64 exec, 1
    buffer_load_dword v29, s[28:31], s60 offen lds
    s_mov_b64 exec, -1
    s_branch L_x1b
L_x1a:
    s_waitcnt vmcnt(12)
    s_barrier
    s_lshl_b32 s60, s4, 12
    s_lshl2_add_u32 s60, s5, s60
    s_add_u32 s60, s60, 33554432
    v_lshlrev_b32 v38, 7, v1
    s_mov_b32 exec_hi, 0
    buffer_store_dword v29, v38, s[28:31], s60 offen sc0 sc1
    s_mov_b32 exec_hi, -1
L_x1b:
    s_lshl2_add_u32 s65, s72, 1024
    s_mov_b32 m0, s65
    s_lshl2_add_u32 s60, s68, s47
    s_mov_b64 exec, 1
    buffer_load_dword v29, s[28:31], s60 offen lds
    s_mov_b64 exec, -1
    s_mov_b32 s68, 1
    s_mov_b32 s69, 3
    s_branch L_wq
L_x2:
    s_lshl2_add_u32 s65, s72, 1032
    s_mov_b32 m0, s65
    s_lshl2_add_u32 s60, s68, s47
    s_mov_b64 exec, 1
    buffer_load_dword v29, s[28:31], s60 offen lds
    s_mov_b64 exec, -1
    s_mov_b32 s68, 2
    s_mov_b32 s69, 5
    s_branch L_wq
L_x3:
    s_mov_b32 s68, 3
    s_mov_b32 s69, 18
    s_bitcmp1_b32 s5, 0
    s_cbranch_scc0 L_nopf
L_pf:
    v_lshlrev_b32 v34, 7, v1
    v_add_u32 v35, 192, v34
    s_mov_b32 s61, s79
    s_cmp_eq_u32 s72, 1
    s_cbranch_scc1 L_pfv
    s_add_u32 s60, s61, s98
    buffer_load_dword v44, v35, s[12:15], s60 offen
    s_add_u32 s61, s61, 8192
    s_and_b32 s61, s61, 0x1ffff
    s_add_u32 s60, s61, s98
    buffer_load_dword v45, v35, s[12:15], s60 offen
    s_add_u32 s61, s61, 8192
    s_and_b32 s61, s61, 0x1ffff
    s_add_u32 s60, s61, s98
    buffer_load_dword v46, v35, s[12:15], s60 offen
    s_add_u32 s61, s61, 8192
    s_and_b32 s61, s61, 0x1ffff
    s_add_u32 s60, s61, s98
    buffer_load_dword v47, v35, s[12:15], s60 offen
    s_add_u32 s61, s61, 8192
    s_and_b32 s61, s61, 0x1ffff
    s_add_u32 s60, s61, s98
    buffer_load_dword v48, v35, s[12:15], s60 offen
    s_add_u32 s61, s61, 8192
    s_and_b32 s61, s61, 0x1ffff
    s_add_u32 s60, s61, s98
    buffer_load_dword v49, v35, s[12:15], s60 offen
    s_add_u32 s61, s61, 8192
    s_and_b32 s61, s61, 0x1ffff
    s_branch L_nopf
L_pfv:
    s_add_u32 s60, s61, s98
    buffer_load_dword v44, v34, s[16:19], s60 offen
    s_add_u32 s61, s61, 8192
    s_and_b32 s61, s61, 0x1ffff
    s_add_u32 s60, s61, s98
    buffer_load_dword v45, v34, s[16:19], s60 offen
    s_add_u32 s61, s61, 8192
    s_and_b32 s61, s61, 0x1ffff
    s_add_u32 s60, s61, s98
    buffer_load_dword v46, v34, s[16:19], s60 offen
    s_add_u32 s61, s61, 8192
    s_and_b32 s61, s61, 0x1ffff
    s_add_u32 s60, s61, s98
    buffer_load_dword v47, v34, s[16:19], s60 offen
    s_add_u32 s61, s61, 8192
    s_and_b32 s61, s61, 0x1ffff
L_nopf:
    s_branch L_wq
L_kv0:
    v_lshl_add_u32 v12, v30, 8, v37
    v_add_u32 v13, 1024, v12
    v_add_u32 v14, 2048, v12
    v_add_u32 v15, 3072, v12
    v_add_u32 v20, v37, v33
    v_add_u32 v21, 8192, v20
    v_add_u32 v22, 16384, v20
    v_add_u32 v23, 24576, v20
    v_and_b32 v35, 15, v1
    v_xor_b32 v35, v35, v32
    v_lshlrev_b32 v35, 4, v35
    v_lshl_add_u32 v11, v32, 8, v35
    v_add_u32 v8, 192, v11
    v_add_u32 v9, 128, v11
    v_add_u32 v10, 64, v11
    s_cmp_eq_u32 s72, 1
    s_cbranch_scc1 L_wo0
    s_lshl_b32 s60, s4, 4
    v_mov_b32 v50, s60
    v_mov_b32 v51, 1
    s_mov_b64 exec, 1
    s_waitcnt vmcnt(40) lgkmcnt(0)
    buffer_atomic_add v51, v50, s[36:39], 0 offen sc1
    s_mov_b64 exec, -1
    s_mov_b32 s69, 16
    s_bitcmp1_b32 s5, 0
    s_cbranch_scc1 L_kv
    v_lshlrev_b32 v34, 7, v1
    s_lshl_b32 s60, s5, 3
    s_add_u32 s60, s60, s4
    s_mul_i32 s60, s60, 36864
    buffer_load_dword v40, v34, s[24:27], s60 offen
    s_add_u32 s60, s60, 8192
    buffer_load_dword v41, v34, s[24:27], s60 offen
    s_add_u32 s60, s60, 8192
    buffer_load_dword v42, v34, s[24:27], s60 offen
    s_add_u32 s60, s60, 8192
    buffer_load_dword v43, v34, s[24:27], s60 offen
    s_add_u32 s60, s60, 8192
    s_mov_b32 exec_hi, 0
    buffer_load_dword v44, v34, s[24:27], s60 offen
    s_add_u32 s60, s60, 8192
    s_mov_b64 exec, -1
L_kv:
    s_cmp_eq_u32 s58, 14
    s_cselect_b32 s45, 7, s45
    s_cmp_ge_u32 s58, 14
    s_cselect_b32 s60, 13, 13
    s_cmp_lt_u32 s58, 3
    s_cselect_b32 s60, 11, s60
    s_add_u32 s66, s60, s58
    s_mul_i32 s64, s45, 17408
    s_add_u32 s64, s64, 7168
    s_lshl2_add_u32 s65, s58, 1112
L_rek:
    s_cmp_ge_i32 s67, s66
    s_cbranch_scc0 L_chkk
    s_mov_b32 s61, 10923
    s_bitcmp1_b32 s61, s58
    s_cbranch_scc0 L_isv
    s_add_u32 s59, s98, s79
    s_add_u32 s79, s79, 16384
    s_and_b32 s79, s79, 0x1ffff
    s_mov_b32 m0, s64
    s_nop 0
    buffer_load_dwordx4 v8, s[12:15], s59 offen offset:0 nt lds
    buffer_load_dwordx4 v9, s[12:15], s59 offen offset:1088 nt lds
    buffer_load_dwordx4 v10, s[12:15], s59 offen offset:2176 nt lds
    buffer_load_dwordx4 v11, s[12:15], s59 offen offset:3264 nt lds
    s_add_u32 m0, s64, 4352
    s_add_u32 s59, s59, 4096
    buffer_load_dwordx4 v8, s[12:15], s59 offen offset:0 nt lds
    buffer_load_dwordx4 v9, s[12:15], s59 offen offset:1088 nt lds
    buffer_load_dwordx4 v10, s[12:15], s59 offen offset:2176 nt lds
    buffer_load_dwordx4 v11, s[12:15], s59 offen offset:3264 nt lds
    s_add_u32 m0, s64, 8704
    s_add_u32 s59, s59, 4096
    buffer_load_dwordx4 v8, s[12:15], s59 offen offset:0 nt lds
    buffer_load_dwordx4 v9, s[12:15], s59 offen offset:1088 nt lds
    buffer_load_dwordx4 v10, s[12:15], s59 offen offset:2176 nt lds
    buffer_load_dwordx4 v11, s[12:15], s59 offen offset:3264 nt lds
    s_add_u32 m0, s64, 13056
    s_add_u32 s59, s59, 4096
    buffer_load_dwordx4 v8, s[12:15], s59 offen offset:0 nt lds
    buffer_load_dwordx4 v9, s[12:15], s59 offen offset:1088 nt lds
    buffer_load_dwordx4 v10, s[12:15], s59 offen offset:2176 nt lds
    buffer_load_dwordx4 v11, s[12:15], s59 offen offset:3264 nt lds
    s_branch L_kvj
L_isv:
    s_add_u32 s59, s98, s80
    s_add_u32 s80, s80, 16384
    s_and_b32 s80, s80, 0x1ffff
    s_mov_b32 m0, s64
    s_nop 0
    buffer_load_dwordx4 v12, s[16:19], s59 offen offset:0 nt lds
    buffer_load_dwordx4 v13, s[16:19], s59 offen offset:1024 nt lds
    buffer_load_dwordx4 v14, s[16:19], s59 offen offset:2048 nt lds
    buffer_load_dwordx4 v15, s[16:19], s59 offen offset:3072 nt lds
    s_add_u32 m0, s64, 8192
    s_add_u32 s59, s59, 128
    buffer_load_dwordx4 v12, s[16:19], s59 offen offset:0 nt lds
    buffer_load_dwordx4 v13, s[16:19], s59 offen offset:1024 nt lds
    buffer_load_dwordx4 v14, s[16:19], s59 offen offset:2048 nt lds
    buffer_load_dwordx4 v15, s[16:19], s59 offen offset:3072 nt lds
    s_add_u32 m0, s64, 4096
    s_add_u32 s59, s59, 8064
    buffer_load_dwordx4 v12, s[16:19], s59 offen offset:0 nt lds
    buffer_load_dwordx4 v13, s[16:19], s59 offen offset:1024 nt lds
    buffer_load_dwordx4 v14, s[16:19], s59 offen offset:2048 nt lds
    buffer_load_dwordx4 v15, s[16:19], s59 offen offset:3072 nt lds
    s_add_u32 m0, s64, 12288
    s_add_u32 s59, s59, 128
    buffer_load_dwordx4 v12, s[16:19], s59 offen offset:0 nt lds
    buffer_load_dwordx4 v13, s[16:19], s59 offen offset:1024 nt lds
    buffer_load_dwordx4 v14, s[16:19], s59 offen offset:2048 nt lds
    buffer_load_dwordx4 v15, s[16:19], s59 offen offset:3072 nt lds
L_kvj:
    s_mov_b32 m0, s65
    s_lshl2_add_u32 s60, s45, s47
    s_mov_b64 exec, 1
    buffer_load_dword v29, s[28:31], s60 offen lds
    s_mov_b64 exec, -1
    s_add_u32 s45, s45, 1
    s_cmp_eq_u32 s45, 9
    s_cselect_b32 s45, 0, s45
    s_add_u32 s58, s58, 1
    s_cmp_lt_u32 s58, s69
    s_cbranch_scc1 L_kv
    buffer_load_dword v52, v50, s[36:39], 0 offen sc0 sc1
L_wo0:
    s_xor_b32 s58, s72, 1
    s_lshl_b32 s43, s7, 7
    s_lshl1_add_u32 s98, s5, s58
    s_mul_i32 s98, s98, 147456
    s_lshl_b32 s42, s58, 2
L_wo:
    s_mov_b32 s40, 1484010000
    s_mov_b32 s41, 6
    s_lshr_b64 s[40:41], s[40:41], s42
    s_and_b32 s45, s40, 15
    s_mul_i32 s64, s45, 17408
    s_add_u32 s64, s64, 7168
    s_add_u32 s66, s58, 29
    s_add_u32 s60, s58, 67
    s_lshr_b32 s60, s60, 1
    s_cmp_ge_u32 s58, 7
    s_cselect_b32 s66, s60, s66
    s_add_u32 s59, s98, s43
    s_lshl2_add_u32 s65, s58, 1176
    s_cmp_lg_u32 s58, 13
    s_cbranch_scc1 L_ncw
    s_waitcnt vmcnt(17)
L_cw:
    v_cmp_le_u32 vcc, 16, v52
    s_cbranch_vccnz L_ncw
    s_lshl_b32 s60, s4, 4
    v_mov_b32 v50, s60
    buffer_load_dword v52, v50, s[36:39], 0 offen sc0 sc1
    s_add_u32 s100, s100, 1
    s_cmp_gt_u32 s100, 0x100000
    s_cbranch_scc1 L_end
    s_waitcnt vmcnt(0)
    s_branch L_cw
L_ncw:
L_rew:
    s_cmp_ge_i32 s67, s66
    s_cbranch_scc0 L_chkw
    s_mov_b32 m0, s64
    s_nop 0
    buffer_load_dwordx4 v20, s[24:27], s59 offen offset:0 lds
    buffer_load_dwordx4 v21, s[24:27], s59 offen offset:1024 lds
    buffer_load_dwordx4 v22, s[24:27], s59 offen offset:2048 lds
    buffer_load_dwordx4 v23, s[24:27], s59 offen offset:3072 lds
    s_add_u32 m0, s64, 4096
    s_add_u32 s59, s59, 36864
    buffer_load_dwordx4 v20, s[24:27], s59 offen offset:0 lds
    buffer_load_dwordx4 v21, s[24:27], s59 offen offset:1024 lds
    buffer_load_dwordx4 v22, s[24:27], s59 offen offset:2048 lds
    buffer_load_dwordx4 v23, s[24:27], s59 offen offset:3072 lds
    s_add_u32 m0, s64, 8192
    s_add_u32 s59, s59, 36864
    buffer_load_dwordx4 v20, s[24:27], s59 offen offset:0 lds
    buffer_load_dwordx4 v21, s[24:27], s59 offen offset:1024 lds
    buffer_load_dwordx4 v22, s[24:27], s59 offen offset:2048 lds
    buffer_load_dwordx4 v23, s[24:27], s59 offen offset:3072 lds
    s_add_u32 m0, s64, 12288
    s_add_u32 s59, s59, 36864
    buffer_load_dwordx4 v20, s[24:27], s59 offen offset:0 lds
    buffer_load_dwordx4 v21, s[24:27], s59 offen offset:1024 lds
    buffer_load_dwordx4 v22, s[24:27], s59 offen offset:2048 lds
    buffer_load_dwordx4 v23, s[24:27], s59 offen offset:3072 lds
    s_mov_b32 m0, s65
    s_lshl2_add_u32 s60, s45, s47
    s_mov_b64 exec, 1
    buffer_load_dword v29, s[28:31], s60 offen lds
    s_mov_b64 exec, -1
    s_add_u32 s43, s43, 128
    s_cmp_eq_u32 s43, 1152
    s_cselect_b32 s43, 0, s43
    s_add_u32 s42, s42, 8
    s_cmp_ge_u32 s42, 36
    s_cselect_b32 s60, 36, 0
    s_sub_u32 s42, s42, s60
    s_add_u32 s58, s58, 2
    s_cmp_lt_u32 s58, 18
    s_cbranch_scc1 L_wo
    s_setprio 0
    s_mov_b32 s66, 42
L_rez:
    s_cmp_ge_i32 s67, s66
    s_cbranch_scc0 L_chkz
    s_branch L_hw0
L_chkq:
    s_barrier
    s_and_b32 s60, s74, 7
    s_lshr_b64 s[74:75], s[74:75], 3
    s_add_u32 s67, s67, s60
    s_branch L_req
L_chkk:
    s_barrier
    s_and_b32 s60, s74, 7
    s_lshr_b64 s[74:75], s[74:75], 3
    s_add_u32 s67, s67, s60
    s_branch L_rek
L_chkw:
    s_barrier
    s_and_b32 s60, s74, 7
    s_lshr_b64 s[74:75], s[74:75], 3
    s_add_u32 s67, s67, s60
    s_branch L_rew
L_chkz:
    s_barrier
    s_and_b32 s60, s74, 7
    s_lshr_b64 s[74:75], s[74:75], 3
    s_add_u32 s67, s67, s60
    s_branch L_rez
L_helper:
    v_lshlrev_b32 v34, 2, v1
    v_add_u32 v36, 8, v1
    v_lshrrev_b32 v36, 6, v36
    ds_write_b32 v34, v36 offset:1024
    s_waitcnt lgkmcnt(0)
    s_barrier
    s_mov_b32 s61, 18
L_hb:
    s_barrier
    s_sub_u32 s61, s61, 1
    s_cmp_lg_u32 s61, 0
    s_cbranch_scc1 L_hb
L_hw0:
    v_mov_b32 v35, 1240
L_hw:
    ds_read_b64 v[36:37], v35
    s_add_u32 s100, s100, 1
    s_cmp_gt_u32 s100, 0x100000
    s_cbranch_scc1 L_end
    s_waitcnt lgkmcnt(0)
    v_min_u32 v34, v36, v37
    v_cmp_ne_u32 vcc, 0, v34
    s_cbranch_vccnz L_red
    s_sleep 2
    s_branch L_hw
L_red:
    s_lshl_b32 s60, s4, 12
    s_add_u32 s60, s60, 33555328
    v_mov_b32 v20, 0
    v_mov_b32 v21, 1
    s_mov_b64 exec, 1
    buffer_atomic_add v21, v20, s[28:31], s60 offen sc0 sc1
    s_mov_b64 exec, -1
L_red2:
    v_lshlrev_b32 v5, 4, v1
    v_and_b32 v2, 31, v1
    v_lshrrev_b32 v3, 5, v1
    v_mul_u32_u24 v6, 1152, v2
    v_lshl_add_u32 v6, v3, 4, v6
    v_and_b32 v4, 15, v1
    v_lshlrev_b32 v4, 2, v4
    v_mov_b32 v24, 0
    v_mov_b32 v25, 0
    v_mov_b32 v26, 0
    v_mov_b32 v27, 0
    v_mov_b32 v28, 0
    v_mov_b32 v29, 0
    v_mov_b32 v30, 0
    v_mov_b32 v31, 0
    s_waitcnt vmcnt(0)
    v_readfirstlane_b32 s73, v21
    s_nop 0
    s_cmp_ge_u32 s73, 72
    s_cbranch_scc1 L_end
    s_lshr_b32 s58, s73, 3
    s_bfe_u32 s61, s73, 0x20001
    s_lshl2_add_u32 s60, s4, s61
    s_lshl_b32 s60, s60, 3
    s_lshr_b32 s61, s58, 1
    s_add_u32 s60, s60, s61
    s_lshl_b32 s60, s60, 7
    s_add_u32 s65, s60, 33554688
    buffer_load_dword v21, v4, s[28:31], s65 offen sc0 sc1
    s_mul_i32 s64, s4, 1179648
    s_lshl_b32 s60, s73, 10
    s_add_u32 s64, s64, s60
    s_bfe_u32 s60, s73, 0x10001
    s_lshl1_add_u32 s60, s4, s60
    s_mul_i32 s66, s60, 36864
    s_bfe_u32 s60, s73, 0x10002
    s_and_b32 s61, s73, 1
    s_lshl1_add_u32 s60, s60, s61
    s_lshl_b32 s60, s60, 5
    s_add_u32 s66, s66, s60
    s_add_u32 s60, s58, s7
    s_cmp_ge_u32 s60, 9
    s_cselect_b32 s61, 9, 0
    s_sub_u32 s60, s60, s61
    s_lshl_b32 s60, s60, 7
    s_add_u32 s66, s66, s60
    s_mov_b32 s68, 0xffff0000
    s_mov_b32 s46, 0
L_rw0:
    s_add_u32 s100, s100, 1
    s_cmp_gt_u32 s100, 0x100000
    s_cbranch_scc1 L_end
    s_mov_b32 s47, 0
    s_waitcnt vmcnt(0)
    s_cmp_eq_u32 s68, -1
    s_cbranch_scc1 L_rpr0
    v_cmp_eq_u32 vcc, 1, v21
    s_andn2_b32 s69, vcc_lo, s68
    s_cbranch_scc0 L_rs0
    s_ff1_i32_b32 s60, s69
    s_bitset1_b32 s68, s60
    s_mul_i32 s61, s60, 73728
    s_add_u32 s61, s61, s64
    buffer_load_dwordx4 v[64:67], v5, s[28:31], s61 offen sc0 sc1
    s_mov_b32 s47, 1
    s_andn2_b32 s69, s69, s68
    s_cbranch_scc0 L_ri0
    s_ff1_i32_b32 s60, s69
    s_bitset1_b32 s68, s60
    s_mul_i32 s61, s60, 73728
    s_add_u32 s61, s61, s64
    buffer_load_dwordx4 v[68:71], v5, s[28:31], s61 offen sc0 sc1
    s_mov_b32 s47, 2
    s_andn2_b32 s69, s69, s68
    s_cbranch_scc0 L_ri0
    s_ff1_i32_b32 s60, s69
    s_bitset1_b32 s68, s60
    s_mul_i32 s61, s60, 73728
    s_add_u32 s61, s61, s64
    buffer_load_dwordx4 v[72:75], v5, s[28:31], s61 offen sc0 sc1
    s_mov_b32 s47, 3
    s_andn2_b32 s69, s69, s68
    s_cbranch_scc0 L_ri0
    s_ff1_i32_b32 s60, s69
    s_bitset1_b32 s68, s60
    s_mul_i32 s61, s60, 73728
    s_add_u32 s61, s61, s64
    buffer_load_dwordx4 v[76:79], v5, s[28:31], s61 offen sc0 sc1
    s_mov_b32 s47, 4
    s_andn2_b32 s69, s69, s68
    s_cbranch_scc0 L_ri0
    s_ff1_i32_b32 s60, s69
    s_bitset1_b32 s68, s60
    s_mul_i32 s61, s60, 73728
    s_add_u32 s61, s61, s64
    buffer_load_dwordx4 v[80:83], v5, s[28:31], s61 offen sc0 sc1
    s_mov_b32 s47, 5
    s_andn2_b32 s69, s69, s68
    s_cbranch_scc0 L_ri0
    s_ff1_i32_b32 s60, s69
    s_bitset1_b32 s68, s60
    s_mul_i32 s61, s60, 73728
    s_add_u32 s61, s61, s64
    buffer_load_dwordx4 v[84:87], v5, s[28:31], s61 offen sc0 sc1
    s_mov_b32 s47, 6
    s_andn2_b32 s69, s69, s68
    s_cbranch_scc0 L_ri0
    s_ff1_i32_b32 s60, s69
    s_bitset1_b32 s68, s60
    s_mul_i32 s61, s60, 73728
    s_add_u32 s61, s61, s64
    buffer_load_dwordx4 v[88:91], v5, s[28:31], s61 offen sc0 sc1
    s_mov_b32 s47, 7
    s_andn2_b32 s69, s69, s68
    s_cbranch_scc0 L_ri0
    s_ff1_i32_b32 s60, s69
    s_bitset1_b32 s68, s60
    s_mul_i32 s61, s60, 73728
    s_add_u32 s61, s61, s64
    buffer_load_dwordx4 v[92:95], v5, s[28:31], s61 offen sc0 sc1
    s_mov_b32 s47, 8
L_ri0:
    s_cmp_eq_u32 s68, -1
    s_cbranch_scc1 L_rpr0
L_rp0:
    buffer_load_dword v21, v4, s[28:31], s65 offen sc0 sc1
L_rpr0:
    s_cmp_le_u32 s46, 0
    s_cbranch_scc1 L_re0
    v_lshlrev_b32 v40, 16, v96
    v_and_b32 v41, 0xffff0000, v96
    v_pk_add_f32 v[24:25], v[24:25], v[40:41]
    v_lshlrev_b32 v42, 16, v97
    v_and_b32 v43, 0xffff0000, v97
    v_pk_add_f32 v[26:27], v[26:27], v[42:43]
    v_lshlrev_b32 v44, 16, v98
    v_and_b32 v45, 0xffff0000, v98
    v_pk_add_f32 v[28:29], v[28:29], v[44:45]
    v_lshlrev_b32 v46, 16, v99
    v_and_b32 v47, 0xffff0000, v99
    v_pk_add_f32 v[30:31], v[30:31], v[46:47]
    s_cmp_le_u32 s46, 1
    s_cbranch_scc1 L_re0
    v_lshlrev_b32 v40, 16, v100
    v_and_b32 v41, 0xffff0000, v100
    v_pk_add_f32 v[24:25], v[24:25], v[40:41]
    v_lshlrev_b32 v42, 16, v101
    v_and_b32 v43, 0xffff0000, v101
    v_pk_add_f32 v[26:27], v[26:27], v[42:43]
    v_lshlrev_b32 v44, 16, v102
    v_and_b32 v45, 0xffff0000, v102
    v_pk_add_f32 v[28:29], v[28:29], v[44:45]
    v_lshlrev_b32 v46, 16, v103
    v_and_b32 v47, 0xffff0000, v103
    v_pk_add_f32 v[30:31], v[30:31], v[46:47]
    s_cmp_le_u32 s46, 2
    s_cbranch_scc1 L_re0
    v_lshlrev_b32 v40, 16, v104
    v_and_b32 v41, 0xffff0000, v104
    v_pk_add_f32 v[24:25], v[24:25], v[40:41]
    v_lshlrev_b32 v42, 16, v105
    v_and_b32 v43, 0xffff0000, v105
    v_pk_add_f32 v[26:27], v[26:27], v[42:43]
    v_lshlrev_b32 v44, 16, v106
    v_and_b32 v45, 0xffff0000, v106
    v_pk_add_f32 v[28:29], v[28:29], v[44:45]
    v_lshlrev_b32 v46, 16, v107
    v_and_b32 v47, 0xffff0000, v107
    v_pk_add_f32 v[30:31], v[30:31], v[46:47]
    s_cmp_le_u32 s46, 3
    s_cbranch_scc1 L_re0
    v_lshlrev_b32 v40, 16, v108
    v_and_b32 v41, 0xffff0000, v108
    v_pk_add_f32 v[24:25], v[24:25], v[40:41]
    v_lshlrev_b32 v42, 16, v109
    v_and_b32 v43, 0xffff0000, v109
    v_pk_add_f32 v[26:27], v[26:27], v[42:43]
    v_lshlrev_b32 v44, 16, v110
    v_and_b32 v45, 0xffff0000, v110
    v_pk_add_f32 v[28:29], v[28:29], v[44:45]
    v_lshlrev_b32 v46, 16, v111
    v_and_b32 v47, 0xffff0000, v111
    v_pk_add_f32 v[30:31], v[30:31], v[46:47]
    s_cmp_le_u32 s46, 4
    s_cbranch_scc1 L_re0
    v_lshlrev_b32 v40, 16, v112
    v_and_b32 v41, 0xffff0000, v112
    v_pk_add_f32 v[24:25], v[24:25], v[40:41]
    v_lshlrev_b32 v42, 16, v113
    v_and_b32 v43, 0xffff0000, v113
    v_pk_add_f32 v[26:27], v[26:27], v[42:43]
    v_lshlrev_b32 v44, 16, v114
    v_and_b32 v45, 0xffff0000, v114
    v_pk_add_f32 v[28:29], v[28:29], v[44:45]
    v_lshlrev_b32 v46, 16, v115
    v_and_b32 v47, 0xffff0000, v115
    v_pk_add_f32 v[30:31], v[30:31], v[46:47]
    s_cmp_le_u32 s46, 5
    s_cbranch_scc1 L_re0
    v_lshlrev_b32 v40, 16, v116
    v_and_b32 v41, 0xffff0000, v116
    v_pk_add_f32 v[24:25], v[24:25], v[40:41]
    v_lshlrev_b32 v42, 16, v117
    v_and_b32 v43, 0xffff0000, v117
    v_pk_add_f32 v[26:27], v[26:27], v[42:43]
    v_lshlrev_b32 v44, 16, v118
    v_and_b32 v45, 0xffff0000, v118
    v_pk_add_f32 v[28:29], v[28:29], v[44:45]
    v_lshlrev_b32 v46, 16, v119
    v_and_b32 v47, 0xffff0000, v119
    v_pk_add_f32 v[30:31], v[30:31], v[46:47]
    s_cmp_le_u32 s46, 6
    s_cbranch_scc1 L_re0
    v_lshlrev_b32 v40, 16, v120
    v_and_b32 v41, 0xffff0000, v120
    v_pk_add_f32 v[24:25], v[24:25], v[40:41]
    v_lshlrev_b32 v42, 16, v121
    v_and_b32 v43, 0xffff0000, v121
    v_pk_add_f32 v[26:27], v[26:27], v[42:43]
    v_lshlrev_b32 v44, 16, v122
    v_and_b32 v45, 0xffff0000, v122
    v_pk_add_f32 v[28:29], v[28:29], v[44:45]
    v_lshlrev_b32 v46, 16, v123
    v_and_b32 v47, 0xffff0000, v123
    v_pk_add_f32 v[30:31], v[30:31], v[46:47]
    s_cmp_le_u32 s46, 7
    s_cbranch_scc1 L_re0
    v_lshlrev_b32 v40, 16, v124
    v_and_b32 v41, 0xffff0000, v124
    v_pk_add_f32 v[24:25], v[24:25], v[40:41]
    v_lshlrev_b32 v42, 16, v125
    v_and_b32 v43, 0xffff0000, v125
    v_pk_add_f32 v[26:27], v[26:27], v[42:43]
    v_lshlrev_b32 v44, 16, v126
    v_and_b32 v45, 0xffff0000, v126
    v_pk_add_f32 v[28:29], v[28:29], v[44:45]
    v_lshlrev_b32 v46, 16, v127
    v_and_b32 v47, 0xffff0000, v127
    v_pk_add_f32 v[30:31], v[30:31], v[46:47]
L_re0:
    s_mov_b32 s46, s47
    s_xor_b32 s60, s68, -1
    s_or_b32 s60, s60, s46
    s_cbranch_scc0 L_rfin
L_rw1:
    s_add_u32 s100, s100, 1
    s_cmp_gt_u32 s100, 0x100000
    s_cbranch_scc1 L_end
    s_mov_b32 s47, 0
    s_waitcnt vmcnt(0)
    s_cmp_eq_u32 s68, -1
    s_cbranch_scc1 L_rpr1
    v_cmp_eq_u32 vcc, 1, v21
    s_andn2_b32 s69, vcc_lo, s68
    s_cbranch_scc0 L_rs1
    s_ff1_i32_b32 s60, s69
    s_bitset1_b32 s68, s60
    s_mul_i32 s61, s60, 73728
    s_add_u32 s61, s61, s64
    buffer_load_dwordx4 v[96:99], v5, s[28:31], s61 offen sc0 sc1
    s_mov_b32 s47, 1
    s_andn2_b32 s69, s69, s68
    s_cbranch_scc0 L_ri1
    s_ff1_i32_b32 s60, s69
    s_bitset1_b32 s68, s60
    s_mul_i32 s61, s60, 73728
    s_add_u32 s61, s61, s64
    buffer_load_dwordx4 v[100:103], v5, s[28:31], s61 offen sc0 sc1
    s_mov_b32 s47, 2
    s_andn2_b32 s69, s69, s68
    s_cbranch_scc0 L_ri1
    s_ff1_i32_b32 s60, s69
    s_bitset1_b32 s68, s60
    s_mul_i32 s61, s60, 73728
    s_add_u32 s61, s61, s64
    buffer_load_dwordx4 v[104:107], v5, s[28:31], s61 offen sc0 sc1
    s_mov_b32 s47, 3
    s_andn2_b32 s69, s69, s68
    s_cbranch_scc0 L_ri1
    s_ff1_i32_b32 s60, s69
    s_bitset1_b32 s68, s60
    s_mul_i32 s61, s60, 73728
    s_add_u32 s61, s61, s64
    buffer_load_dwordx4 v[108:111], v5, s[28:31], s61 offen sc0 sc1
    s_mov_b32 s47, 4
    s_andn2_b32 s69, s69, s68
    s_cbranch_scc0 L_ri1
    s_ff1_i32_b32 s60, s69
    s_bitset1_b32 s68, s60
    s_mul_i32 s61, s60, 73728
    s_add_u32 s61, s61, s64
    buffer_load_dwordx4 v[112:115], v5, s[28:31], s61 offen sc0 sc1
    s_mov_b32 s47, 5
    s_andn2_b32 s69, s69, s68
    s_cbranch_scc0 L_ri1
    s_ff1_i32_b32 s60, s69
    s_bitset1_b32 s68, s60
    s_mul_i32 s61, s60, 73728
    s_add_u32 s61, s61, s64
    buffer_load_dwordx4 v[116:119], v5, s[28:31], s61 offen sc0 sc1
    s_mov_b32 s47, 6
    s_andn2_b32 s69, s69, s68
    s_cbranch_scc0 L_ri1
    s_ff1_i32_b32 s60, s69
    s_bitset1_b32 s68, s60
    s_mul_i32 s61, s60, 73728
    s_add_u32 s61, s61, s64
    buffer_load_dwordx4 v[120:123], v5, s[28:31], s61 offen sc0 sc1
    s_mov_b32 s47, 7
    s_andn2_b32 s69, s69, s68
    s_cbranch_scc0 L_ri1
    s_ff1_i32_b32 s60, s69
    s_bitset1_b32 s68, s60
    s_mul_i32 s61, s60, 73728
    s_add_u32 s61, s61, s64
    buffer_load_dwordx4 v[124:127], v5, s[28:31], s61 offen sc0 sc1
    s_mov_b32 s47, 8
L_ri1:
    s_cmp_eq_u32 s68, -1
    s_cbranch_scc1 L_rpr1
L_rp1:
    buffer_load_dword v21, v4, s[28:31], s65 offen sc0 sc1
L_rpr1:
    s_cmp_le_u32 s46, 0
    s_cbranch_scc1 L_re1
    v_lshlrev_b32 v40, 16, v64
    v_and_b32 v41, 0xffff0000, v64
    v_pk_add_f32 v[24:25], v[24:25], v[40:41]
    v_lshlrev_b32 v42, 16, v65
    v_and_b32 v43, 0xffff0000, v65
    v_pk_add_f32 v[26:27], v[26:27], v[42:43]
    v_lshlrev_b32 v44, 16, v66
    v_and_b32 v45, 0xffff0000, v66
    v_pk_add_f32 v[28:29], v[28:29], v[44:45]
    v_lshlrev_b32 v46, 16, v67
    v_and_b32 v47, 0xffff0000, v67
    v_pk_add_f32 v[30:31], v[30:31], v[46:47]
    s_cmp_le_u32 s46, 1
    s_cbranch_scc1 L_re1
    v_lshlrev_b32 v40, 16, v68
    v_and_b32 v41, 0xffff0000, v68
    v_pk_add_f32 v[24:25], v[24:25], v[40:41]
    v_lshlrev_b32 v42, 16, v69
    v_and_b32 v43, 0xffff0000, v69
    v_pk_add_f32 v[26:27], v[26:27], v[42:43]
    v_lshlrev_b32 v44, 16, v70
    v_and_b32 v45, 0xffff0000, v70
    v_pk_add_f32 v[28:29], v[28:29], v[44:45]
    v_lshlrev_b32 v46, 16, v71
    v_and_b32 v47, 0xffff0000, v71
    v_pk_add_f32 v[30:31], v[30:31], v[46:47]
    s_cmp_le_u32 s46, 2
    s_cbranch_scc1 L_re1
    v_lshlrev_b32 v40, 16, v72
    v_and_b32 v41, 0xffff0000, v72
    v_pk_add_f32 v[24:25], v[24:25], v[40:41]
    v_lshlrev_b32 v42, 16, v73
    v_and_b32 v43, 0xffff0000, v73
    v_pk_add_f32 v[26:27], v[26:27], v[42:43]
    v_lshlrev_b32 v44, 16, v74
    v_and_b32 v45, 0xffff0000, v74
    v_pk_add_f32 v[28:29], v[28:29], v[44:45]
    v_lshlrev_b32 v46, 16, v75
    v_and_b32 v47, 0xffff0000, v75
    v_pk_add_f32 v[30:31], v[30:31], v[46:47]
    s_cmp_le_u32 s46, 3
    s_cbranch_scc1 L_re1
    v_lshlrev_b32 v40, 16, v76
    v_and_b32 v41, 0xffff0000, v76
    v_pk_add_f32 v[24:25], v[24:25], v[40:41]
    v_lshlrev_b32 v42, 16, v77
    v_and_b32 v43, 0xffff0000, v77
    v_pk_add_f32 v[26:27], v[26:27], v[42:43]
    v_lshlrev_b32 v44, 16, v78
    v_and_b32 v45, 0xffff0000, v78
    v_pk_add_f32 v[28:29], v[28:29], v[44:45]
    v_lshlrev_b32 v46, 16, v79
    v_and_b32 v47, 0xffff0000, v79
    v_pk_add_f32 v[30:31], v[30:31], v[46:47]
    s_cmp_le_u32 s46, 4
    s_cbranch_scc1 L_re1
    v_lshlrev_b32 v40, 16, v80
    v_and_b32 v41, 0xffff0000, v80
    v_pk_add_f32 v[24:25], v[24:25], v[40:41]
    v_lshlrev_b32 v42, 16, v81
    v_and_b32 v43, 0xffff0000, v81
    v_pk_add_f32 v[26:27], v[26:27], v[42:43]
    v_lshlrev_b32 v44, 16, v82
    v_and_b32 v45, 0xffff0000, v82
    v_pk_add_f32 v[28:29], v[28:29], v[44:45]
    v_lshlrev_b32 v46, 16, v83
    v_and_b32 v47, 0xffff0000, v83
    v_pk_add_f32 v[30:31], v[30:31], v[46:47]
    s_cmp_le_u32 s46, 5
    s_cbranch_scc1 L_re1
    v_lshlrev_b32 v40, 16, v84
    v_and_b32 v41, 0xffff0000, v84
    v_pk_add_f32 v[24:25], v[24:25], v[40:41]
    v_lshlrev_b32 v42, 16, v85
    v_and_b32 v43, 0xffff0000, v85
    v_pk_add_f32 v[26:27], v[26:27], v[42:43]
    v_lshlrev_b32 v44, 16, v86
    v_and_b32 v45, 0xffff0000, v86
    v_pk_add_f32 v[28:29], v[28:29], v[44:45]
    v_lshlrev_b32 v46, 16, v87
    v_and_b32 v47, 0xffff0000, v87
    v_pk_add_f32 v[30:31], v[30:31], v[46:47]
    s_cmp_le_u32 s46, 6
    s_cbranch_scc1 L_re1
    v_lshlrev_b32 v40, 16, v88
    v_and_b32 v41, 0xffff0000, v88
    v_pk_add_f32 v[24:25], v[24:25], v[40:41]
    v_lshlrev_b32 v42, 16, v89
    v_and_b32 v43, 0xffff0000, v89
    v_pk_add_f32 v[26:27], v[26:27], v[42:43]
    v_lshlrev_b32 v44, 16, v90
    v_and_b32 v45, 0xffff0000, v90
    v_pk_add_f32 v[28:29], v[28:29], v[44:45]
    v_lshlrev_b32 v46, 16, v91
    v_and_b32 v47, 0xffff0000, v91
    v_pk_add_f32 v[30:31], v[30:31], v[46:47]
    s_cmp_le_u32 s46, 7
    s_cbranch_scc1 L_re1
    v_lshlrev_b32 v40, 16, v92
    v_and_b32 v41, 0xffff0000, v92
    v_pk_add_f32 v[24:25], v[24:25], v[40:41]
    v_lshlrev_b32 v42, 16, v93
    v_and_b32 v43, 0xffff0000, v93
    v_pk_add_f32 v[26:27], v[26:27], v[42:43]
    v_lshlrev_b32 v44, 16, v94
    v_and_b32 v45, 0xffff0000, v94
    v_pk_add_f32 v[28:29], v[28:29], v[44:45]
    v_lshlrev_b32 v46, 16, v95
    v_and_b32 v47, 0xffff0000, v95
    v_pk_add_f32 v[30:31], v[30:31], v[46:47]
L_re1:
    s_mov_b32 s46, s47
    s_xor_b32 s60, s68, -1
    s_or_b32 s60, s60, s46
    s_cbranch_scc0 L_rfin
    s_branch L_rw0
L_rs0:
    s_sleep 2
    s_branch L_rp0
L_rs1:
    s_sleep 2
    s_branch L_rp1
L_rfin:
    v_cvt_pk_bf16_f32 v48, v24, v25
    v_cvt_pk_bf16_f32 v49, v26, v27
    v_cvt_pk_bf16_f32 v50, v28, v29
    v_cvt_pk_bf16_f32 v51, v30, v31
    buffer_store_dwordx4 v[48:51], v6, s[32:35], s66 offen
    s_endpgm
L_comp:
    s_setprio 1
    s_lshr_b32 s57, s3, 1
    s_and_b32 s58, s3, 1
    v_mov_b32 v3, 1024
    v_mov_b32 v5, 1
    v_and_b32 v10, 31, v1
    v_lshrrev_b32 v11, 5, v1
    v_bfe_u32 v12, v1, 2, 2
    v_bfe_u32 v15, v1, 4, 1
    v_lshlrev_b32 v15, 5, v15
    v_bfe_u32 v9, v1, 3, 1
    v_lshl_add_u32 v15, v9, 6, v15
    v_lshl_add_u32 v15, v12, 7, v15
    v_subrev_u32 v15, 1, v15
    v_and_b32 v13, 3, v1
    v_lshl_add_u32 v13, v13, 3, v15
    v_and_b32 v14, 1, v1
    v_lshl_add_u32 v14, v14, 4, v15
    v_bfe_u32 v9, v1, 1, 1
    v_lshl_add_u32 v14, v9, 3, v14
    v_bfe_u32 v15, v1, 1, 3
    v_xor_b32 v15, v15, v11
    v_lshlrev_b32 v15, 4, v15
    v_lshl_add_u32 v15, v10, 7, v15
    s_lshl_b32 s60, s58, 12
    s_add_u32 s60, s60, 3072
    v_add_u32 v16, s60, v15
    v_xor_b32 v17, 32, v16
    v_xor_b32 v18, 64, v16
    v_xor_b32 v19, 96, v16
    v_add_u32 v0, 24576, v16
    v_lshl_add_u32 v15, v11, 12, v14
    s_lshl_b32 s60, s57, 11
    v_add_u32 v8, s60, v15
    s_barrier
    s_waitcnt vmcnt(0)
    s_lshl_b32 s98, s4, 12
    s_lshl_b32 s60, s5, 2
    s_add_u32 s98, s98, s60
    s_add_u32 s98, s98, 33554432
    s_lshl_b32 s60, s3, 10
    s_add_u32 s98, s98, s60
    s_lshl_b32 s60, s58, 2
    v_add_u32 v9, s60, v3
L_xwait:
    ds_read_b32 v24, v9
    s_add_u32 s100, s100, 1
    s_cmp_gt_u32 s100, 0x100000
    s_cbranch_scc1 L_end
    s_waitcnt lgkmcnt(0)
    v_cmp_eq_u32 vcc, 0, v24
    s_cbranch_vccnz L_xwait
    ds_read_b32 v4, v3 offset:16
    ds_read_b128 v[112:115], v16 offset:0
    ds_read_b128 v[116:119], v17 offset:0
    ds_read_b128 v[120:123], v18 offset:0
    ds_read_b128 v[124:127], v19 offset:0
    ds_read_b128 v[128:131], v16 offset:8192
    ds_read_b128 v[132:135], v17 offset:8192
    ds_read_b128 v[136:139], v18 offset:8192
    ds_read_b128 v[140:143], v19 offset:8192
    ds_read_b128 v[144:147], v16 offset:16384
    ds_read_b128 v[148:151], v17 offset:16384
    ds_read_b128 v[152:155], v18 offset:16384
    ds_read_b128 v[156:159], v19 offset:16384
    s_waitcnt lgkmcnt(12)
    v_cmp_eq_u32 vcc, 0, v4
    s_cbranch_vccnz L_poll1
L_pollret1:
    v_add_u32 v6, v4, v8
    v_xor_b32 v7, 64, v6
    ds_read_b32 v4, v3 offset:20
    ds_read_b64_tr_b16 v[16:17], v6 offset:0
    ds_read_b64_tr_b16 v[18:19], v6 offset:512
    s_waitcnt lgkmcnt(14)
    ds_read_b64_tr_b16 v[20:21], v7 offset:0
    s_waitcnt lgkmcnt(14)
    ds_read_b64_tr_b16 v[22:23], v7 offset:512
    s_waitcnt lgkmcnt(14)
    ds_read_b64_tr_b16 v[24:25], v6 offset:1024
    s_waitcnt lgkmcnt(14)
    ds_read_b64_tr_b16 v[26:27], v6 offset:1536
    s_waitcnt lgkmcnt(14)
    ds_read_b64_tr_b16 v[28:29], v7 offset:1024
    s_waitcnt lgkmcnt(14)
    ds_read_b64_tr_b16 v[30:31], v7 offset:1536
    s_waitcnt lgkmcnt(14)
    ds_read_b64_tr_b16 v[32:33], v6 offset:8192
    s_waitcnt lgkmcnt(14)
    ds_read_b64_tr_b16 v[34:35], v6 offset:8704
    s_waitcnt lgkmcnt(14)
    ds_read_b64_tr_b16 v[36:37], v7 offset:8192
    s_waitcnt lgkmcnt(14)
    ds_read_b64_tr_b16 v[38:39], v7 offset:8704
    s_waitcnt lgkmcnt(8)
    v_mfma_f32_32x32x16_bf16 v[48:63], v[16:19], v[112:115], 0
    ds_read_b64_tr_b16 v[40:41], v6 offset:9216
    ds_read_b64_tr_b16 v[42:43], v6 offset:9728
    v_mfma_f32_32x32x16_bf16 v[64:79], v[20:23], v[112:115], 0
    ds_read_b64_tr_b16 v[44:45], v7 offset:9216
    ds_read_b64_tr_b16 v[46:47], v7 offset:9728
    v_cmp_eq_u32 vcc, 0, v4
    s_waitcnt lgkmcnt(8)
    v_mfma_f32_32x32x16_bf16 v[80:95], v[24:27], v[112:115], 0
    s_cbranch_vccnz L_poll2
L_pollret2:
    v_mfma_f32_32x32x16_bf16 v[96:111], v[28:31], v[112:115], 0
    v_add_u32 v6, v4, v8
    v_xor_b32 v7, 64, v6
    ds_read_b64_tr_b16 v[16:17], v6 offset:0
    ds_read_b64_tr_b16 v[18:19], v6 offset:512
    s_waitcnt lgkmcnt(6)
    v_mfma_f32_32x32x16_bf16 v[48:63], v[32:35], v[116:119], v[48:63]
    ds_read_b64_tr_b16 v[20:21], v7 offset:0
    ds_read_b64_tr_b16 v[22:23], v7 offset:512
    ds_read_b64_tr_b16 v[24:25], v6 offset:1024
    ds_read_b64_tr_b16 v[26:27], v6 offset:1536
    v_mfma_f32_32x32x16_bf16 v[64:79], v[36:39], v[116:119], v[64:79]
    ds_read_b64_tr_b16 v[28:29], v7 offset:1024
    ds_read_b64_tr_b16 v[30:31], v7 offset:1536
    ds_read_b32 v4, v3 offset:24
    s_waitcnt lgkmcnt(9)
    v_mfma_f32_32x32x16_bf16 v[80:95], v[40:43], v[116:119], v[80:95]
    ds_read_b64_tr_b16 v[32:33], v6 offset:8192
    ds_read_b64_tr_b16 v[34:35], v6 offset:8704
    v_mfma_f32_32x32x16_bf16 v[96:111], v[44:47], v[116:119], v[96:111]
    ds_read_b64_tr_b16 v[36:37], v7 offset:8192
    ds_read_b64_tr_b16 v[38:39], v7 offset:8704
    ds_read_b32 v2, v9 offset:8
    s_waitcnt lgkmcnt(10)
    v_mfma_f32_32x32x16_bf16 v[48:63], v[16:19], v[120:123], v[48:63]
    ds_read_b64_tr_b16 v[40:41], v6 offset:9216
    ds_read_b64_tr_b16 v[42:43], v6 offset:9728
    v_mfma_f32_32x32x16_bf16 v[64:79], v[20:23], v[120:123], v[64:79]
    ds_read_b64_tr_b16 v[44:45], v7 offset:9216
    ds_read_b64_tr_b16 v[46:47], v7 offset:9728
    s_waitcnt lgkmcnt(9)
    v_cmp_eq_u32 vcc, 0, v4
    v_mfma_f32_32x32x16_bf16 v[80:95], v[24:27], v[120:123], v[80:95]
    s_cbranch_vccnz L_poll3
L_pollret3:
    v_mfma_f32_32x32x16_bf16 v[96:111], v[28:31], v[120:123], v[96:111]
    s_waitcnt lgkmcnt(4)
    v_cmp_eq_u32 s[62:63], 0, v2
    v_add_u32 v6, v4, v8
    v_xor_b32 v7, 64, v6
    v_mfma_f32_32x32x16_bf16 v[48:63], v[32:35], v[124:127], v[48:63]
    ds_read_b64_tr_b16 v[16:17], v6 offset:0
    ds_read_b64_tr_b16 v[18:19], v6 offset:512
    ds_read_b64_tr_b16 v[20:21], v7 offset:0
    ds_read_b64_tr_b16 v[22:23], v7 offset:512
    s_cmp_lg_u64 s[62:63], 0
    s_cbranch_scc1 L_x2p
L_x2r:
    v_mfma_f32_32x32x16_bf16 v[64:79], v[36:39], v[124:127], v[64:79]
    ds_read_b64_tr_b16 v[24:25], v6 offset:1024
    ds_read_b64_tr_b16 v[26:27], v6 offset:1536
    ds_read_b64_tr_b16 v[28:29], v7 offset:1024
    ds_read_b64_tr_b16 v[30:31], v7 offset:1536
    s_waitcnt lgkmcnt(8)
    v_mfma_f32_32x32x16_bf16 v[80:95], v[40:43], v[124:127], v[80:95]
    ds_read_b32 v4, v3 offset:28
    v_xor_b32 v12, 0, v0
    ds_read_b128 v[160:163], v12 offset:0
    ds_read_b128 v[176:179], v12 offset:8192
    ds_read_b128 v[192:195], v12 offset:16384
    v_mfma_f32_32x32x16_bf16 v[96:111], v[44:47], v[124:127], v[96:111]
    ds_read_b64_tr_b16 v[32:33], v6 offset:8192
    ds_read_b64_tr_b16 v[34:35], v6 offset:8704
    ds_read_b64_tr_b16 v[36:37], v7 offset:8192
    s_waitcnt lgkmcnt(14)
    ds_read_b64_tr_b16 v[38:39], v7 offset:8704
    s_waitcnt lgkmcnt(12)
    v_mfma_f32_32x32x16_bf16 v[48:63], v[16:19], v[128:131], v[48:63]
    ds_read_b128 v[208:211], v12 offset:24576
    ds_read_b128 v[224:227], v12 offset:32768
    ds_read_b64_tr_b16 v[40:41], v6 offset:9216
    s_waitcnt lgkmcnt(14)
    ds_read_b64_tr_b16 v[42:43], v6 offset:9728
    v_mfma_f32_32x32x16_bf16 v[64:79], v[20:23], v[128:131], v[64:79]
    s_waitcnt lgkmcnt(14)
    ds_read_b64_tr_b16 v[44:45], v7 offset:9216
    s_waitcnt lgkmcnt(14)
    ds_read_b64_tr_b16 v[46:47], v7 offset:9728
    s_waitcnt lgkmcnt(14)
    ds_read_b128 v[240:243], v12 offset:40960
    s_waitcnt lgkmcnt(14)
    v_cmp_eq_u32 vcc, 0, v4
    v_mfma_f32_32x32x16_bf16 v[80:95], v[24:27], v[128:131], v[80:95]
    v_xor_b32 v12, 32, v0
    ds_read_b128 v[164:167], v12 offset:0
    s_waitcnt lgkmcnt(14)
    ds_read_b128 v[180:183], v12 offset:8192
    v_mfma_f32_32x32x16_bf16 v[96:111], v[28:31], v[128:131], v[96:111]
    s_cbranch_vccnz L_poll4
L_pollret4:
    s_waitcnt lgkmcnt(9)
    v_mfma_f32_32x32x16_bf16 v[48:63], v[32:35], v[132:135], v[48:63]
    v_add_u32 v6, v4, v8
    v_xor_b32 v7, 64, v6
    ds_read_b64_tr_b16 v[16:17], v6 offset:0
    ds_read_b64_tr_b16 v[18:19], v6 offset:512
    ds_read_b64_tr_b16 v[20:21], v7 offset:0
    ds_read_b64_tr_b16 v[22:23], v7 offset:512
    ds_read_b128 v[196:199], v12 offset:16384
    v_mfma_f32_32x32x16_bf16 v[64:79], v[36:39], v[132:135], v[64:79]
    ds_read_b128 v[212:215], v12 offset:24576
    s_waitcnt lgkmcnt(14)
    ds_read_b64_tr_b16 v[24:25], v6 offset:1024
    s_waitcnt lgkmcnt(14)
    ds_read_b64_tr_b16 v[26:27], v6 offset:1536
    s_waitcnt lgkmcnt(14)
    ds_read_b128 v[228:231], v12 offset:32768
    s_waitcnt lgkmcnt(12)
    v_mfma_f32_32x32x16_bf16 v[80:95], v[40:43], v[132:135], v[80:95]
    ds_read_b64_tr_b16 v[28:29], v7 offset:1024
    ds_read_b64_tr_b16 v[30:31], v7 offset:1536
    ds_read_b32 v4, v3 offset:32
    s_barrier
    v_mfma_f32_32x32x16_bf16 v[96:111], v[44:47], v[132:135], v[96:111]
    s_waitcnt lgkmcnt(14)
    ds_read_b128 v[244:247], v12 offset:40960
    s_waitcnt lgkmcnt(14)
    ds_read_b64_tr_b16 v[32:33], v6 offset:8192
    s_waitcnt lgkmcnt(14)
    ds_read_b64_tr_b16 v[34:35], v6 offset:8704
    v_xor_b32 v12, 64, v0
    s_waitcnt lgkmcnt(11)
    v_mfma_f32_32x32x16_bf16 v[48:63], v[16:19], v[136:139], v[48:63]
    ds_read_b64_tr_b16 v[36:37], v7 offset:8192
    ds_read_b64_tr_b16 v[38:39], v7 offset:8704
    ds_read_b128 v[168:171], v12 offset:0
    ds_read_b128 v[184:187], v12 offset:8192
    s_waitcnt lgkmcnt(14)
    ds_read_b128 v[200:203], v12 offset:16384
    v_mfma_f32_32x32x16_bf16 v[64:79], v[20:23], v[136:139], v[64:79]
    s_waitcnt lgkmcnt(14)
    ds_read_b64_tr_b16 v[40:41], v6 offset:9216
    s_waitcnt lgkmcnt(14)
    ds_read_b64_tr_b16 v[42:43], v6 offset:9728
    s_waitcnt lgkmcnt(14)
    ds_read_b64_tr_b16 v[44:45], v7 offset:9216
    s_waitcnt lgkmcnt(14)
    ds_read_b64_tr_b16 v[46:47], v7 offset:9728
    s_waitcnt lgkmcnt(13)
    v_mfma_f32_32x32x16_bf16 v[80:95], v[24:27], v[136:139], v[80:95]
    ds_read_b128 v[216:219], v12 offset:24576
    s_waitcnt lgkmcnt(13)
    v_cmp_eq_u32 vcc, 0, v4
    ds_read_b128 v[232:235], v12 offset:32768
    v_mfma_f32_32x32x16_bf16 v[96:111], v[28:31], v[136:139], v[96:111]
    s_cbranch_vccnz L_poll5
L_pollret5:
    s_waitcnt lgkmcnt(9)
    v_mfma_f32_32x32x16_bf16 v[48:63], v[32:35], v[140:143], v[48:63]
    v_add_u32 v6, v4, v8
    v_xor_b32 v7, 64, v6
    ds_read_b64_tr_b16 v[16:17], v6 offset:0
    ds_read_b64_tr_b16 v[18:19], v6 offset:512
    ds_read_b64_tr_b16 v[20:21], v7 offset:0
    ds_read_b64_tr_b16 v[22:23], v7 offset:512
    ds_read_b128 v[248:251], v12 offset:40960
    v_mfma_f32_32x32x16_bf16 v[64:79], v[36:39], v[140:143], v[64:79]
    v_xor_b32 v12, 96, v0
    ds_read_b128 v[172:175], v12 offset:0
    s_waitcnt lgkmcnt(14)
    ds_read_b128 v[188:191], v12 offset:8192
    s_waitcnt lgkmcnt(14)
    ds_read_b128 v[204:207], v12 offset:16384
    s_waitcnt lgkmcnt(10)
    v_mfma_f32_32x32x16_bf16 v[80:95], v[40:43], v[140:143], v[80:95]
    ds_read_b64_tr_b16 v[24:25], v6 offset:1024
    ds_read_b64_tr_b16 v[26:27], v6 offset:1536
    ds_read_b64_tr_b16 v[28:29], v7 offset:1024
    ds_read_b64_tr_b16 v[30:31], v7 offset:1536
    ds_read_b32 v4, v3 offset:36
    v_mfma_f32_32x32x16_bf16 v[96:111], v[44:47], v[140:143], v[96:111]
    s_waitcnt lgkmcnt(14)
    ds_read_b128 v[220:223], v12 offset:24576
    s_waitcnt lgkmcnt(14)
    ds_read_b64_tr_b16 v[32:33], v6 offset:8192
    s_waitcnt lgkmcnt(14)
    ds_read_b64_tr_b16 v[34:35], v6 offset:8704
    s_waitcnt lgkmcnt(14)
    ds_read_b128 v[236:239], v12 offset:32768
    s_waitcnt lgkmcnt(13)
    v_mfma_f32_32x32x16_bf16 v[48:63], v[16:19], v[144:147], v[48:63]
    ds_read_b64_tr_b16 v[36:37], v7 offset:8192
    ds_read_b64_tr_b16 v[38:39], v7 offset:8704
    s_waitcnt lgkmcnt(14)
    ds_read_b128 v[252:255], v12 offset:40960
    s_waitcnt lgkmcnt(14)
    ds_read_b64_tr_b16 v[40:41], v6 offset:9216
    s_waitcnt lgkmcnt(14)
    ds_read_b64_tr_b16 v[42:43], v6 offset:9728
    v_mfma_f32_32x32x16_bf16 v[64:79], v[20:23], v[144:147], v[64:79]
    s_waitcnt lgkmcnt(14)
    ds_read_b64_tr_b16 v[44:45], v7 offset:9216
    s_waitcnt lgkmcnt(14)
    ds_read_b64_tr_b16 v[46:47], v7 offset:9728
    s_waitcnt lgkmcnt(11)
    v_cmp_eq_u32 vcc, 0, v4
    v_mfma_f32_32x32x16_bf16 v[80:95], v[24:27], v[144:147], v[80:95]
    s_cbranch_vccnz L_poll6
L_pollret6:
    v_mfma_f32_32x32x16_bf16 v[96:111], v[28:31], v[144:147], v[96:111]
    v_add_u32 v6, v4, v8
    v_xor_b32 v7, 64, v6
    ds_read_b64_tr_b16 v[16:17], v6 offset:0
    ds_read_b64_tr_b16 v[18:19], v6 offset:512
    s_waitcnt lgkmcnt(7)
    v_mfma_f32_32x32x16_bf16 v[48:63], v[32:35], v[148:151], v[48:63]
    ds_read_b64_tr_b16 v[20:21], v7 offset:0
    ds_read_b64_tr_b16 v[22:23], v7 offset:512
    ds_read_b64_tr_b16 v[24:25], v6 offset:1024
    ds_read_b64_tr_b16 v[26:27], v6 offset:1536
    v_mfma_f32_32x32x16_bf16 v[64:79], v[36:39], v[148:151], v[64:79]
    ds_read_b64_tr_b16 v[28:29], v7 offset:1024
    ds_read_b64_tr_b16 v[30:31], v7 offset:1536
    ds_read_b32 v4, v3 offset:40
    s_waitcnt lgkmcnt(9)
    v_mfma_f32_32x32x16_bf16 v[80:95], v[40:43], v[148:151], v[80:95]
    s_barrier
    v_mfma_f32_32x32x16_bf16 v[96:111], v[44:47], v[148:151], v[96:111]
    ds_read_b64_tr_b16 v[32:33], v6 offset:8192
    ds_read_b64_tr_b16 v[34:35], v6 offset:8704
    ds_read_b64_tr_b16 v[36:37], v7 offset:8192
    ds_read_b64_tr_b16 v[38:39], v7 offset:8704
    s_waitcnt lgkmcnt(9)
    v_mfma_f32_32x32x16_bf16 v[48:63], v[16:19], v[152:155], v[48:63]
    ds_read_b64_tr_b16 v[40:41], v6 offset:9216
    ds_read_b64_tr_b16 v[42:43], v6 offset:9728
    v_mfma_f32_32x32x16_bf16 v[64:79], v[20:23], v[152:155], v[64:79]
    ds_read_b64_tr_b16 v[44:45], v7 offset:9216
    ds_read_b64_tr_b16 v[46:47], v7 offset:9728
    s_waitcnt lgkmcnt(8)
    v_cmp_eq_u32 vcc, 0, v4
    v_mfma_f32_32x32x16_bf16 v[80:95], v[24:27], v[152:155], v[80:95]
    s_cbranch_vccnz L_poll7
L_pollret7:
    v_mfma_f32_32x32x16_bf16 v[96:111], v[28:31], v[152:155], v[96:111]
    v_add_u32 v6, v4, v8
    v_xor_b32 v7, 64, v6
    ds_read_b64_tr_b16 v[16:17], v6 offset:0
    ds_read_b64_tr_b16 v[18:19], v6 offset:512
    s_waitcnt lgkmcnt(6)
    v_mfma_f32_32x32x16_bf16 v[48:63], v[32:35], v[156:159], v[48:63]
    ds_read_b64_tr_b16 v[20:21], v7 offset:0
    ds_read_b64_tr_b16 v[22:23], v7 offset:512
    ds_read_b64_tr_b16 v[24:25], v6 offset:1024
    ds_read_b64_tr_b16 v[26:27], v6 offset:1536
    v_mfma_f32_32x32x16_bf16 v[64:79], v[36:39], v[156:159], v[64:79]
    ds_read_b64_tr_b16 v[28:29], v7 offset:1024
    ds_read_b64_tr_b16 v[30:31], v7 offset:1536
    ds_read_b32 v4, v3 offset:44
    s_waitcnt lgkmcnt(9)
    v_mfma_f32_32x32x16_bf16 v[80:95], v[40:43], v[156:159], v[80:95]
    ds_read_b64_tr_b16 v[32:33], v6 offset:8192
    ds_read_b64_tr_b16 v[34:35], v6 offset:8704
    v_mfma_f32_32x32x16_bf16 v[96:111], v[44:47], v[156:159], v[96:111]
    ds_read_b64_tr_b16 v[36:37], v7 offset:8192
    ds_read_b64_tr_b16 v[38:39], v7 offset:8704
    s_waitcnt lgkmcnt(9)
    v_mfma_f32_32x32x16_bf16 v[48:63], v[16:19], v[160:163], v[48:63]
    ds_read_b64_tr_b16 v[40:41], v6 offset:9216
    ds_read_b64_tr_b16 v[42:43], v6 offset:9728
    v_mfma_f32_32x32x16_bf16 v[64:79], v[20:23], v[160:163], v[64:79]
    ds_read_b64_tr_b16 v[44:45], v7 offset:9216
    ds_read_b64_tr_b16 v[46:47], v7 offset:9728
    s_waitcnt lgkmcnt(8)
    v_cmp_eq_u32 vcc, 0, v4
    v_mfma_f32_32x32x16_bf16 v[80:95], v[24:27], v[160:163], v[80:95]
    s_cbranch_vccnz L_poll8
L_pollret8:
    v_mfma_f32_32x32x16_bf16 v[96:111], v[28:31], v[160:163], v[96:111]
    v_add_u32 v6, v4, v8
    v_xor_b32 v7, 64, v6
    ds_read_b64_tr_b16 v[16:17], v6 offset:0
    ds_read_b64_tr_b16 v[18:19], v6 offset:512
    s_waitcnt lgkmcnt(6)
    v_mfma_f32_32x32x16_bf16 v[48:63], v[32:35], v[164:167], v[48:63]
    ds_read_b64_tr_b16 v[20:21], v7 offset:0
    ds_read_b64_tr_b16 v[22:23], v7 offset:512
    ds_read_b64_tr_b16 v[24:25], v6 offset:1024
    ds_read_b64_tr_b16 v[26:27], v6 offset:1536
    v_mfma_f32_32x32x16_bf16 v[64:79], v[36:39], v[164:167], v[64:79]
    ds_read_b64_tr_b16 v[28:29], v7 offset:1024
    ds_read_b64_tr_b16 v[30:31], v7 offset:1536
    ds_read_b32 v4, v3 offset:48
    s_waitcnt lgkmcnt(9)
    v_mfma_f32_32x32x16_bf16 v[80:95], v[40:43], v[164:167], v[80:95]
    ds_read_b64_tr_b16 v[32:33], v6 offset:8192
    ds_read_b64_tr_b16 v[34:35], v6 offset:8704
    v_mfma_f32_32x32x16_bf16 v[96:111], v[44:47], v[164:167], v[96:111]
    ds_read_b64_tr_b16 v[36:37], v7 offset:8192
    ds_read_b64_tr_b16 v[38:39], v7 offset:8704
    s_waitcnt lgkmcnt(9)
    v_mfma_f32_32x32x16_bf16 v[48:63], v[16:19], v[168:171], v[48:63]
    ds_read_b64_tr_b16 v[40:41], v6 offset:9216
    ds_read_b64_tr_b16 v[42:43], v6 offset:9728
    v_mfma_f32_32x32x16_bf16 v[64:79], v[20:23], v[168:171], v[64:79]
    ds_read_b64_tr_b16 v[44:45], v7 offset:9216
    ds_read_b64_tr_b16 v[46:47], v7 offset:9728
    s_waitcnt lgkmcnt(8)
    v_cmp_eq_u32 vcc, 0, v4
    v_mfma_f32_32x32x16_bf16 v[80:95], v[24:27], v[168:171], v[80:95]
    s_cbranch_vccnz L_poll9
L_pollret9:
    v_mfma_f32_32x32x16_bf16 v[96:111], v[28:31], v[168:171], v[96:111]
    v_add_u32 v6, v4, v8
    v_xor_b32 v7, 64, v6
    ds_read_b64_tr_b16 v[16:17], v6 offset:0
    ds_read_b64_tr_b16 v[18:19], v6 offset:512
    s_waitcnt lgkmcnt(6)
    v_mfma_f32_32x32x16_bf16 v[48:63], v[32:35], v[172:175], v[48:63]
    ds_read_b64_tr_b16 v[20:21], v7 offset:0
    ds_read_b64_tr_b16 v[22:23], v7 offset:512
    ds_read_b64_tr_b16 v[24:25], v6 offset:1024
    ds_read_b64_tr_b16 v[26:27], v6 offset:1536
    v_mfma_f32_32x32x16_bf16 v[64:79], v[36:39], v[172:175], v[64:79]
    ds_read_b64_tr_b16 v[28:29], v7 offset:1024
    ds_read_b64_tr_b16 v[30:31], v7 offset:1536
    ds_read_b32 v4, v3 offset:52
    s_waitcnt lgkmcnt(9)
    v_mfma_f32_32x32x16_bf16 v[80:95], v[40:43], v[172:175], v[80:95]
    ds_read_b64_tr_b16 v[32:33], v6 offset:8192
    ds_read_b64_tr_b16 v[34:35], v6 offset:8704
    v_mfma_f32_32x32x16_bf16 v[96:111], v[44:47], v[172:175], v[96:111]
    ds_read_b64_tr_b16 v[36:37], v7 offset:8192
    ds_read_b64_tr_b16 v[38:39], v7 offset:8704
    s_waitcnt lgkmcnt(9)
    v_mfma_f32_32x32x16_bf16 v[48:63], v[16:19], v[176:179], v[48:63]
    ds_read_b64_tr_b16 v[40:41], v6 offset:9216
    ds_read_b64_tr_b16 v[42:43], v6 offset:9728
    v_mfma_f32_32x32x16_bf16 v[64:79], v[20:23], v[176:179], v[64:79]
    ds_read_b64_tr_b16 v[44:45], v7 offset:9216
    ds_read_b64_tr_b16 v[46:47], v7 offset:9728
    s_waitcnt lgkmcnt(8)
    v_cmp_eq_u32 vcc, 0, v4
    v_mfma_f32_32x32x16_bf16 v[80:95], v[24:27], v[176:179], v[80:95]
    s_cbranch_vccnz L_poll10
L_pollret10:
    v_mfma_f32_32x32x16_bf16 v[96:111], v[28:31], v[176:179], v[96:111]
    v_add_u32 v6, v4, v8
    v_xor_b32 v7, 64, v6
    ds_read_b64_tr_b16 v[16:17], v6 offset:0
    ds_read_b64_tr_b16 v[18:19], v6 offset:512
    s_waitcnt lgkmcnt(6)
    v_mfma_f32_32x32x16_bf16 v[48:63], v[32:35], v[180:183], v[48:63]
    ds_read_b64_tr_b16 v[20:21], v7 offset:0
    ds_read_b64_tr_b16 v[22:23], v7 offset:512
    ds_read_b64_tr_b16 v[24:25], v6 offset:1024
    ds_read_b64_tr_b16 v[26:27], v6 offset:1536
    v_mfma_f32_32x32x16_bf16 v[64:79], v[36:39], v[180:183], v[64:79]
    ds_read_b64_tr_b16 v[28:29], v7 offset:1024
    ds_read_b64_tr_b16 v[30:31], v7 offset:1536
    ds_read_b32 v4, v3 offset:56
    s_waitcnt lgkmcnt(9)
    v_mfma_f32_32x32x16_bf16 v[80:95], v[40:43], v[180:183], v[80:95]
    s_barrier
    v_mfma_f32_32x32x16_bf16 v[96:111], v[44:47], v[180:183], v[96:111]
    ds_read_b64_tr_b16 v[32:33], v6 offset:8192
    ds_read_b64_tr_b16 v[34:35], v6 offset:8704
    ds_read_b64_tr_b16 v[36:37], v7 offset:8192
    ds_read_b64_tr_b16 v[38:39], v7 offset:8704
    s_waitcnt lgkmcnt(9)
    v_mfma_f32_32x32x16_bf16 v[48:63], v[16:19], v[184:187], v[48:63]
    ds_read_b64_tr_b16 v[40:41], v6 offset:9216
    ds_read_b64_tr_b16 v[42:43], v6 offset:9728
    v_mov_b32 v112, 0
    v_mfma_f32_32x32x16_bf16 v[64:79], v[20:23], v[184:187], v[64:79]
    ds_read_b64_tr_b16 v[44:45], v7 offset:9216
    ds_read_b64_tr_b16 v[46:47], v7 offset:9728
    s_waitcnt lgkmcnt(8)
    v_cmp_eq_u32 vcc, 0, v4
    v_mov_b32 v113, 0
    v_mfma_f32_32x32x16_bf16 v[80:95], v[24:27], v[184:187], v[80:95]
    s_cbranch_vccnz L_poll11
L_pollret11:
    v_mov_b32 v114, 0
    v_mfma_f32_32x32x16_bf16 v[96:111], v[28:31], v[184:187], v[96:111]
    v_add_u32 v6, v4, v8
    v_xor_b32 v7, 64, v6
    ds_read_b64_tr_b16 v[16:17], v6 offset:0
    ds_read_b64_tr_b16 v[18:19], v6 offset:512
    s_waitcnt lgkmcnt(6)
    v_mfma_f32_32x32x16_bf16 v[48:63], v[32:35], v[188:191], v[48:63]
    ds_read_b64_tr_b16 v[20:21], v7 offset:0
    ds_read_b64_tr_b16 v[22:23], v7 offset:512
    ds_read_b64_tr_b16 v[24:25], v6 offset:1024
    ds_read_b64_tr_b16 v[26:27], v6 offset:1536
    v_mov_b32 v115, 0
    v_mfma_f32_32x32x16_bf16 v[64:79], v[36:39], v[188:191], v[64:79]
    ds_read_b64_tr_b16 v[28:29], v7 offset:1024
    ds_read_b64_tr_b16 v[30:31], v7 offset:1536
    ds_read_b32 v4, v3 offset:60
    v_mov_b32 v116, 0
    s_waitcnt lgkmcnt(9)
    v_mfma_f32_32x32x16_bf16 v[80:95], v[40:43], v[188:191], v[80:95]
    ds_read_b64_tr_b16 v[32:33], v6 offset:8192
    ds_read_b64_tr_b16 v[34:35], v6 offset:8704
    v_mov_b32 v117, 0
    v_mov_b32 v118, 0
    v_mfma_f32_32x32x16_bf16 v[96:111], v[44:47], v[188:191], v[96:111]
    ds_read_b64_tr_b16 v[36:37], v7 offset:8192
    ds_read_b64_tr_b16 v[38:39], v7 offset:8704
    v_mov_b32 v119, 0
    s_waitcnt lgkmcnt(9)
    v_mfma_f32_32x32x16_bf16 v[48:63], v[16:19], v[192:195], v[48:63]
    ds_read_b64_tr_b16 v[40:41], v6 offset:9216
    ds_read_b64_tr_b16 v[42:43], v6 offset:9728
    v_mov_b32 v120, 0
    v_mfma_f32_32x32x16_bf16 v[64:79], v[20:23], v[192:195], v[64:79]
    ds_read_b64_tr_b16 v[44:45], v7 offset:9216
    ds_read_b64_tr_b16 v[46:47], v7 offset:9728
    s_waitcnt lgkmcnt(8)
    v_cmp_eq_u32 vcc, 0, v4
    v_mov_b32 v121, 0
    v_mfma_f32_32x32x16_bf16 v[80:95], v[24:27], v[192:195], v[80:95]
    s_cbranch_vccnz L_poll12
L_pollret12:
    v_mov_b32 v122, 0
    v_mfma_f32_32x32x16_bf16 v[96:111], v[28:31], v[192:195], v[96:111]
    v_add_u32 v6, v4, v8
    v_xor_b32 v7, 64, v6
    ds_read_b64_tr_b16 v[16:17], v6 offset:0
    ds_read_b64_tr_b16 v[18:19], v6 offset:512
    s_waitcnt lgkmcnt(6)
    v_mfma_f32_32x32x16_bf16 v[48:63], v[32:35], v[196:199], v[48:63]
    ds_read_b64_tr_b16 v[20:21], v7 offset:0
    ds_read_b64_tr_b16 v[22:23], v7 offset:512
    ds_read_b64_tr_b16 v[24:25], v6 offset:1024
    ds_read_b64_tr_b16 v[26:27], v6 offset:1536
    v_mov_b32 v123, 0
    v_mfma_f32_32x32x16_bf16 v[64:79], v[36:39], v[196:199], v[64:79]
    ds_read_b64_tr_b16 v[28:29], v7 offset:1024
    ds_read_b64_tr_b16 v[30:31], v7 offset:1536
    ds_read_b32 v4, v3 offset:64
    v_mov_b32 v124, 0
    s_waitcnt lgkmcnt(9)
    v_mfma_f32_32x32x16_bf16 v[80:95], v[40:43], v[196:199], v[80:95]
    ds_read_b64_tr_b16 v[32:33], v6 offset:8192
    ds_read_b64_tr_b16 v[34:35], v6 offset:8704
    v_mov_b32 v125, 0
    v_mov_b32 v126, 0
    v_mfma_f32_32x32x16_bf16 v[96:111], v[44:47], v[196:199], v[96:111]
    ds_read_b64_tr_b16 v[36:37], v7 offset:8192
    ds_read_b64_tr_b16 v[38:39], v7 offset:8704
    v_mov_b32 v127, 0
    s_waitcnt lgkmcnt(9)
    v_mfma_f32_32x32x16_bf16 v[48:63], v[16:19], v[200:203], v[48:63]
    ds_read_b64_tr_b16 v[40:41], v6 offset:9216
    ds_read_b64_tr_b16 v[42:43], v6 offset:9728
    v_mov_b32 v128, 0
    v_mfma_f32_32x32x16_bf16 v[64:79], v[20:23], v[200:203], v[64:79]
    ds_read_b64_tr_b16 v[44:45], v7 offset:9216
    ds_read_b64_tr_b16 v[46:47], v7 offset:9728
    s_waitcnt lgkmcnt(8)
    v_cmp_eq_u32 vcc, 0, v4
    v_mov_b32 v129, 0
    v_mfma_f32_32x32x16_bf16 v[80:95], v[24:27], v[200:203], v[80:95]
    s_cbranch_vccnz L_poll13
L_pollret13:
    v_mov_b32 v130, 0
    v_mfma_f32_32x32x16_bf16 v[96:111], v[28:31], v[200:203], v[96:111]
    v_add_u32 v6, v4, v8
    v_xor_b32 v7, 64, v6
    ds_read_b64_tr_b16 v[16:17], v6 offset:0
    ds_read_b64_tr_b16 v[18:19], v6 offset:512
    s_waitcnt lgkmcnt(6)
    v_mfma_f32_32x32x16_bf16 v[48:63], v[32:35], v[204:207], v[48:63]
    ds_read_b64_tr_b16 v[20:21], v7 offset:0
    ds_read_b64_tr_b16 v[22:23], v7 offset:512
    ds_read_b64_tr_b16 v[24:25], v6 offset:1024
    ds_read_b64_tr_b16 v[26:27], v6 offset:1536
    v_mov_b32 v131, 0
    v_mfma_f32_32x32x16_bf16 v[64:79], v[36:39], v[204:207], v[64:79]
    ds_read_b64_tr_b16 v[28:29], v7 offset:1024
    ds_read_b64_tr_b16 v[30:31], v7 offset:1536
    ds_read_b32 v4, v3 offset:68
    v_mov_b32 v132, 0
    s_waitcnt lgkmcnt(9)
    v_mfma_f32_32x32x16_bf16 v[80:95], v[40:43], v[204:207], v[80:95]
    s_barrier
    v_mfma_f32_32x32x16_bf16 v[96:111], v[44:47], v[204:207], v[96:111]
    ds_read_b64_tr_b16 v[32:33], v6 offset:8192
    ds_read_b64_tr_b16 v[34:35], v6 offset:8704
    ds_read_b64_tr_b16 v[36:37], v7 offset:8192
    ds_read_b64_tr_b16 v[38:39], v7 offset:8704
    s_waitcnt lgkmcnt(9)
    v_mfma_f32_32x32x16_bf16 v[48:63], v[16:19], v[208:211], v[48:63]
    ds_read_b64_tr_b16 v[40:41], v6 offset:9216
    ds_read_b64_tr_b16 v[42:43], v6 offset:9728
    v_mov_b32 v133, 0
    v_mov_b32 v134, 0
    v_mov_b32 v135, 0
    v_mfma_f32_32x32x16_bf16 v[64:79], v[20:23], v[208:211], v[64:79]
    ds_read_b64_tr_b16 v[44:45], v7 offset:9216
    ds_read_b64_tr_b16 v[46:47], v7 offset:9728
    s_waitcnt lgkmcnt(8)
    v_cmp_eq_u32 vcc, 0, v4
    v_mov_b32 v136, 0
    v_mfma_f32_32x32x16_bf16 v[80:95], v[24:27], v[208:211], v[80:95]
    s_cbranch_vccnz L_poll14
L_pollret14:
    v_mov_b32 v137, 0
    v_mfma_f32_32x32x16_bf16 v[96:111], v[28:31], v[208:211], v[96:111]
    v_add_u32 v6, v4, v8
    v_xor_b32 v7, 64, v6
    ds_read_b64_tr_b16 v[16:17], v6 offset:0
    ds_read_b64_tr_b16 v[18:19], v6 offset:512
    s_waitcnt lgkmcnt(6)
    v_mfma_f32_32x32x16_bf16 v[48:63], v[32:35], v[212:215], v[48:63]
    ds_read_b64_tr_b16 v[20:21], v7 offset:0
    ds_read_b64_tr_b16 v[22:23], v7 offset:512
    ds_read_b64_tr_b16 v[24:25], v6 offset:1024
    ds_read_b64_tr_b16 v[26:27], v6 offset:1536
    s_mov_b32 s66, 1040356334
    v_mfma_f32_32x32x16_bf16 v[64:79], v[36:39], v[212:215], v[64:79]
    ds_read_b64_tr_b16 v[28:29], v7 offset:1024
    ds_read_b64_tr_b16 v[30:31], v7 offset:1536
    ds_read_b32 v4, v3 offset:72
    s_mov_b32 s67, 1040356334
    s_waitcnt lgkmcnt(9)
    v_mfma_f32_32x32x16_bf16 v[80:95], v[40:43], v[212:215], v[80:95]
    ds_read_b64_tr_b16 v[32:33], v6 offset:8192
    ds_read_b64_tr_b16 v[34:35], v6 offset:8704
    s_mov_b32 s65, 1090519040
    s_mov_b32 s64, 0
    s_mov_b32 s59, 0
    v_mfma_f32_32x32x16_bf16 v[96:111], v[44:47], v[212:215], v[96:111]
    ds_read_b64_tr_b16 v[36:37], v7 offset:8192
    ds_read_b64_tr_b16 v[38:39], v7 offset:8704
    v_and_b32 v15, 3, v1
    v_xor_b32 v9, v15, v11
    s_waitcnt lgkmcnt(9)
    v_mfma_f32_32x32x16_bf16 v[48:63], v[16:19], v[216:219], v[48:63]
    ds_read_b64_tr_b16 v[40:41], v6 offset:9216
    ds_read_b64_tr_b16 v[42:43], v6 offset:9728
    v_lshlrev_b32 v9, 4, v9
    v_lshl_add_u32 v9, v15, 8, v9
    v_lshrrev_b32 v15, 2, v10
    v_mfma_f32_32x32x16_bf16 v[64:79], v[20:23], v[216:219], v[64:79]
    ds_read_b64_tr_b16 v[44:45], v7 offset:9216
    ds_read_b64_tr_b16 v[46:47], v7 offset:9728
    s_waitcnt lgkmcnt(8)
    v_cmp_eq_u32 vcc, 0, v4
    v_mul_u32_u24 v15, 1088, v15
    v_mfma_f32_32x32x16_bf16 v[80:95], v[24:27], v[216:219], v[80:95]
    s_cbranch_vccnz L_poll15
L_pollret15:
    v_add3_u32 v9, v9, v15, -1
    v_mfma_f32_32x32x16_bf16 v[96:111], v[28:31], v[216:219], v[96:111]
    v_add_u32 v6, v4, v8
    v_xor_b32 v7, 64, v6
    ds_read_b64_tr_b16 v[16:17], v6 offset:0
    ds_read_b64_tr_b16 v[18:19], v6 offset:512
    s_waitcnt lgkmcnt(6)
    v_mfma_f32_32x32x16_bf16 v[48:63], v[32:35], v[220:223], v[48:63]
    ds_read_b64_tr_b16 v[20:21], v7 offset:0
    ds_read_b64_tr_b16 v[22:23], v7 offset:512
    ds_read_b64_tr_b16 v[24:25], v6 offset:1024
    ds_read_b64_tr_b16 v[26:27], v6 offset:1536
    v_lshrrev_b32 v15, 2, v1
    v_mfma_f32_32x32x16_bf16 v[64:79], v[36:39], v[220:223], v[64:79]
    ds_read_b64_tr_b16 v[28:29], v7 offset:1024
    ds_read_b64_tr_b16 v[30:31], v7 offset:1536
    ds_read_b32 v4, v3 offset:76
    v_xor_b32 v15, v15, v1
    s_waitcnt lgkmcnt(9)
    v_mfma_f32_32x32x16_bf16 v[80:95], v[40:43], v[220:223], v[80:95]
    ds_read_b64_tr_b16 v[32:33], v6 offset:8192
    ds_read_b64_tr_b16 v[34:35], v6 offset:8704
    v_bfe_u32 v15, v15, 2, 1
    v_subrev_u32 v15, 1, v15
    v_and_b32 v2, 0x3f803f80, v15
    v_mfma_f32_32x32x16_bf16 v[96:111], v[44:47], v[220:223], v[96:111]
    ds_read_b64_tr_b16 v[36:37], v7 offset:8192
    ds_read_b64_tr_b16 v[38:39], v7 offset:8704
    v_mov_b32 v138, 0
    v_mov_b32 v139, 0
    s_waitcnt lgkmcnt(9)
    v_mfma_f32_32x32x16_bf16 v[48:63], v[16:19], v[224:227], v[48:63]
    ds_read_b64_tr_b16 v[40:41], v6 offset:9216
    ds_read_b64_tr_b16 v[42:43], v6 offset:9728
    v_mov_b32 v140, 0
    v_mov_b32 v141, 0
    v_mov_b32 v142, 0
    v_mfma_f32_32x32x16_bf16 v[64:79], v[20:23], v[224:227], v[64:79]
    ds_read_b64_tr_b16 v[44:45], v7 offset:9216
    ds_read_b64_tr_b16 v[46:47], v7 offset:9728
    s_waitcnt lgkmcnt(8)
    v_cmp_eq_u32 vcc, 0, v4
    v_mov_b32 v143, 0
    v_mfma_f32_32x32x16_bf16 v[80:95], v[24:27], v[224:227], v[80:95]
    s_cbranch_vccnz L_poll16
L_pollret16:
    v_mov_b32 v144, 0
    v_mfma_f32_32x32x16_bf16 v[96:111], v[28:31], v[224:227], v[96:111]
    v_add_u32 v6, v4, v8
    v_xor_b32 v7, 64, v6
    ds_read_b64_tr_b16 v[16:17], v6 offset:0
    ds_read_b64_tr_b16 v[18:19], v6 offset:512
    s_waitcnt lgkmcnt(6)
    v_mfma_f32_32x32x16_bf16 v[48:63], v[32:35], v[228:231], v[48:63]
    ds_read_b64_tr_b16 v[20:21], v7 offset:0
    ds_read_b64_tr_b16 v[22:23], v7 offset:512
    ds_read_b64_tr_b16 v[24:25], v6 offset:1024
    ds_read_b64_tr_b16 v[26:27], v6 offset:1536
    v_mov_b32 v145, 0
    v_mfma_f32_32x32x16_bf16 v[64:79], v[36:39], v[228:231], v[64:79]
    ds_read_b64_tr_b16 v[28:29], v7 offset:1024
    ds_read_b64_tr_b16 v[30:31], v7 offset:1536
    ds_read_b32 v4, v3 offset:80
    v_mov_b32 v146, 0
    s_waitcnt lgkmcnt(9)
    v_mfma_f32_32x32x16_bf16 v[80:95], v[40:43], v[228:231], v[80:95]
    ds_read_b64_tr_b16 v[32:33], v6 offset:8192
    ds_read_b64_tr_b16 v[34:35], v6 offset:8704
    v_mov_b32 v147, 0
    v_mov_b32 v148, 0
    v_mov_b32 v149, 0
    v_mfma_f32_32x32x16_bf16 v[96:111], v[44:47], v[228:231], v[96:111]
    ds_read_b64_tr_b16 v[36:37], v7 offset:8192
    ds_read_b64_tr_b16 v[38:39], v7 offset:8704
    v_mov_b32 v150, 0
    v_mov_b32 v151, 0
    s_waitcnt lgkmcnt(9)
    v_mfma_f32_32x32x16_bf16 v[48:63], v[16:19], v[232:235], v[48:63]
    ds_read_b64_tr_b16 v[40:41], v6 offset:9216
    ds_read_b64_tr_b16 v[42:43], v6 offset:9728
    v_mov_b32 v152, 0
    v_mov_b32 v153, 0
    v_mov_b32 v154, 0
    v_mfma_f32_32x32x16_bf16 v[64:79], v[20:23], v[232:235], v[64:79]
    ds_read_b64_tr_b16 v[44:45], v7 offset:9216
    ds_read_b64_tr_b16 v[46:47], v7 offset:9728
    s_waitcnt lgkmcnt(8)
    v_cmp_eq_u32 vcc, 0, v4
    v_mov_b32 v155, 0
    v_mfma_f32_32x32x16_bf16 v[80:95], v[24:27], v[232:235], v[80:95]
    s_cbranch_vccnz L_poll17
L_pollret17:
    v_mov_b32 v156, 0
    v_mfma_f32_32x32x16_bf16 v[96:111], v[28:31], v[232:235], v[96:111]
    v_add_u32 v6, v4, v8
    v_xor_b32 v7, 64, v6
    ds_read_b64_tr_b16 v[16:17], v6 offset:0
    ds_read_b64_tr_b16 v[18:19], v6 offset:512
    s_waitcnt lgkmcnt(6)
    v_mfma_f32_32x32x16_bf16 v[48:63], v[32:35], v[236:239], v[48:63]
    ds_read_b64_tr_b16 v[20:21], v7 offset:0
    ds_read_b64_tr_b16 v[22:23], v7 offset:512
    ds_read_b64_tr_b16 v[24:25], v6 offset:1024
    ds_read_b64_tr_b16 v[26:27], v6 offset:1536
    v_mov_b32 v157, 0
    v_mfma_f32_32x32x16_bf16 v[64:79], v[36:39], v[236:239], v[64:79]
    ds_read_b64_tr_b16 v[28:29], v7 offset:1024
    ds_read_b64_tr_b16 v[30:31], v7 offset:1536
    ds_read_b32 v4, v3 offset:84
    v_mov_b32 v158, 0
    s_waitcnt lgkmcnt(9)
    v_mfma_f32_32x32x16_bf16 v[80:95], v[40:43], v[236:239], v[80:95]
    ds_read_b64_tr_b16 v[32:33], v6 offset:8192
    ds_read_b64_tr_b16 v[34:35], v6 offset:8704
    v_mov_b32 v159, 0
    v_mov_b32 v160, 0
    v_mov_b32 v161, 0
    v_mfma_f32_32x32x16_bf16 v[96:111], v[44:47], v[236:239], v[96:111]
    ds_read_b64_tr_b16 v[36:37], v7 offset:8192
    ds_read_b64_tr_b16 v[38:39], v7 offset:8704
    v_mov_b32 v162, 0
    v_mov_b32 v163, 0
    s_waitcnt lgkmcnt(9)
    v_mfma_f32_32x32x16_bf16 v[48:63], v[16:19], v[240:243], v[48:63]
    ds_read_b64_tr_b16 v[40:41], v6 offset:9216
    ds_read_b64_tr_b16 v[42:43], v6 offset:9728
    v_mov_b32 v164, 0
    v_mov_b32 v165, 0
    v_mov_b32 v166, 0
    v_mfma_f32_32x32x16_bf16 v[64:79], v[20:23], v[240:243], v[64:79]
    ds_read_b64_tr_b16 v[44:45], v7 offset:9216
    ds_read_b64_tr_b16 v[46:47], v7 offset:9728
    s_waitcnt lgkmcnt(8)
    v_cmp_eq_u32 vcc, 0, v4
    v_mov_b32 v167, 0
    v_mfma_f32_32x32x16_bf16 v[80:95], v[24:27], v[240:243], v[80:95]
    s_cbranch_vccnz L_poll18
L_pollret18:
    v_mov_b32 v168, 0
    v_mfma_f32_32x32x16_bf16 v[96:111], v[28:31], v[240:243], v[96:111]
    v_add_u32 v6, v4, v8
    v_xor_b32 v7, 64, v6
    ds_read_b64_tr_b16 v[16:17], v6 offset:0
    ds_read_b64_tr_b16 v[18:19], v6 offset:512
    s_waitcnt lgkmcnt(6)
    v_mfma_f32_32x32x16_bf16 v[48:63], v[32:35], v[244:247], v[48:63]
    ds_read_b64_tr_b16 v[20:21], v7 offset:0
    ds_read_b64_tr_b16 v[22:23], v7 offset:512
    ds_read_b64_tr_b16 v[24:25], v6 offset:1024
    ds_read_b64_tr_b16 v[26:27], v6 offset:1536
    v_mov_b32 v169, 0
    v_mfma_f32_32x32x16_bf16 v[64:79], v[36:39], v[244:247], v[64:79]
    ds_read_b64_tr_b16 v[28:29], v7 offset:1024
    ds_read_b64_tr_b16 v[30:31], v7 offset:1536
    ds_read_b32 v4, v3 offset:88
    v_mov_b32 v170, 0
    s_waitcnt lgkmcnt(9)
    v_mfma_f32_32x32x16_bf16 v[80:95], v[40:43], v[244:247], v[80:95]
    ds_read_b64_tr_b16 v[32:33], v6 offset:8192
    ds_read_b64_tr_b16 v[34:35], v6 offset:8704
    v_mov_b32 v171, 0
    v_mov_b32 v172, 0
    v_mov_b32 v173, 0
    v_mfma_f32_32x32x16_bf16 v[96:111], v[44:47], v[244:247], v[96:111]
    ds_read_b64_tr_b16 v[36:37], v7 offset:8192
    ds_read_b64_tr_b16 v[38:39], v7 offset:8704
    v_mov_b32 v174, 0
    v_mov_b32 v175, 0
    s_waitcnt lgkmcnt(9)
    v_mfma_f32_32x32x16_bf16 v[48:63], v[16:19], v[248:251], v[48:63]
    ds_read_b64_tr_b16 v[40:41], v6 offset:9216
    ds_read_b64_tr_b16 v[42:43], v6 offset:9728
    v_mfma_f32_32x32x16_bf16 v[64:79], v[20:23], v[248:251], v[64:79]
    ds_read_b64_tr_b16 v[44:45], v7 offset:9216
    ds_read_b64_tr_b16 v[46:47], v7 offset:9728
    s_waitcnt lgkmcnt(9)
    v_mfma_f32_32x32x16_bf16 v[80:95], v[24:27], v[248:251], v[80:95]
    v_mfma_f32_32x32x16_bf16 v[96:111], v[28:31], v[248:251], v[96:111]
    s_waitcnt lgkmcnt(4)
    v_mfma_f32_32x32x16_bf16 v[48:63], v[32:35], v[252:255], v[48:63]
    v_mfma_f32_32x32x16_bf16 v[64:79], v[36:39], v[252:255], v[64:79]
    s_waitcnt lgkmcnt(0)
    v_mfma_f32_32x32x16_bf16 v[80:95], v[40:43], v[252:255], v[80:95]
    s_barrier
    v_mfma_f32_32x32x16_bf16 v[96:111], v[44:47], v[252:255], v[96:111]
    v_lshl_add_u32 v8, v11, 9, v13
    v_cmp_eq_u32 vcc, 0, v4
    s_cbranch_vccnz L_poll19
L_pollret19:
    v_add_u32 v6, v4, v9
    v_xor_b32 v7, 32, v6
    v_add_u32 v3, 92, v3
    ds_read_b128 v[16:19], v6 offset:0
    ds_read_b128 v[20:23], v7 offset:0
    ds_read_b128 v[24:27], v6 offset:64
    ds_read_b128 v[28:31], v7 offset:64
    ds_read_b128 v[32:35], v6 offset:128
    ds_read_b128 v[36:39], v7 offset:128
    v_pk_mul_f32 v[48:49], v[48:49], s[66:67]
    v_pk_mul_f32 v[50:51], v[50:51], s[66:67]
    v_cvt_pk_bf16_f32 v48, v48, v49
    v_pk_mul_f32 v[52:53], v[52:53], s[66:67]
    v_cvt_pk_bf16_f32 v49, v50, v51
    v_pk_mul_f32 v[54:55], v[54:55], s[66:67]
    v_cvt_pk_bf16_f32 v50, v52, v53
    v_cvt_pk_bf16_f32 v51, v54, v55
    v_pk_mul_f32 v[56:57], v[56:57], s[66:67]
    v_pk_mul_f32 v[58:59], v[58:59], s[66:67]
    v_cvt_pk_bf16_f32 v56, v56, v57
    v_pk_mul_f32 v[60:61], v[60:61], s[66:67]
    v_cvt_pk_bf16_f32 v57, v58, v59
    v_pk_mul_f32 v[62:63], v[62:63], s[66:67]
    v_cvt_pk_bf16_f32 v58, v60, v61
    v_cvt_pk_bf16_f32 v59, v62, v63
    s_waitcnt lgkmcnt(4)
    v_mfma_f32_32x32x16_bf16 v[176:191], v[16:19], v[48:51], 0
    v_mul_f32 v64, s66, v64
    v_mul_f32 v65, s66, v65
    v_mul_f32 v66, s66, v66
    v_mul_f32 v67, s66, v67
    v_cvt_pk_bf16_f32 v64, v64, v65
    v_mul_f32 v68, s66, v68
    v_mul_f32 v69, s66, v69
    v_cvt_pk_bf16_f32 v65, v66, v67
    v_mul_f32 v70, s66, v70
    v_mul_f32 v71, s66, v71
    v_cvt_pk_bf16_f32 v66, v68, v69
    v_cvt_pk_bf16_f32 v67, v70, v71
    v_mfma_f32_32x32x16_bf16 v[176:191], v[20:23], v[56:59], v[176:191]
    v_mul_f32 v72, s66, v72
    v_mul_f32 v73, s66, v73
    v_mul_f32 v74, s66, v74
    v_mul_f32 v75, s66, v75
    v_cvt_pk_bf16_f32 v72, v72, v73
    v_mul_f32 v76, s66, v76
    v_mul_f32 v77, s66, v77
    v_cvt_pk_bf16_f32 v73, v74, v75
    v_mul_f32 v78, s66, v78
    v_mul_f32 v79, s66, v79
    v_cvt_pk_bf16_f32 v74, v76, v77
    v_cvt_pk_bf16_f32 v75, v78, v79
    s_waitcnt lgkmcnt(2)
    v_mfma_f32_32x32x16_bf16 v[176:191], v[24:27], v[64:67], v[176:191]
    ds_read_b128 v[40:43], v6 offset:192
    ds_read_b128 v[44:47], v7 offset:192
    v_mul_f32 v80, s66, v80
    v_mul_f32 v81, s66, v81
    v_mul_f32 v82, s66, v82
    v_mul_f32 v83, s66, v83
    v_cvt_pk_bf16_f32 v80, v80, v81
    v_mul_f32 v84, s66, v84
    v_mul_f32 v85, s66, v85
    v_cvt_pk_bf16_f32 v81, v82, v83
    v_mul_f32 v86, s66, v86
    v_mul_f32 v87, s66, v87
    v_cvt_pk_bf16_f32 v82, v84, v85
    v_cvt_pk_bf16_f32 v83, v86, v87
    v_mfma_f32_32x32x16_bf16 v[176:191], v[28:31], v[72:75], v[176:191]
    v_mul_f32 v88, s66, v88
    v_mul_f32 v89, s66, v89
    v_mul_f32 v90, s66, v90
    v_mul_f32 v91, s66, v91
    v_cvt_pk_bf16_f32 v88, v88, v89
    v_mul_f32 v92, s66, v92
    v_mul_f32 v93, s66, v93
    v_cvt_pk_bf16_f32 v89, v90, v91
    v_mul_f32 v94, s66, v94
    v_mul_f32 v95, s66, v95
    v_cvt_pk_bf16_f32 v90, v92, v93
    v_cvt_pk_bf16_f32 v91, v94, v95
    s_waitcnt lgkmcnt(2)
    v_mfma_f32_32x32x16_bf16 v[176:191], v[32:35], v[80:83], v[176:191]
    ds_read_b128 v[16:19], v6 offset:8704
    ds_read_b128 v[20:23], v7 offset:8704
    v_mul_f32 v96, s66, v96
    v_mul_f32 v97, s66, v97
    v_mul_f32 v98, s66, v98
    v_mul_f32 v99, s66, v99
    v_cvt_pk_bf16_f32 v96, v96, v97
    v_mul_f32 v100, s66, v100
    v_mul_f32 v101, s66, v101
    v_cvt_pk_bf16_f32 v97, v98, v99
    v_mul_f32 v102, s66, v102
    v_mul_f32 v103, s66, v103
    v_cvt_pk_bf16_f32 v98, v100, v101
    v_cvt_pk_bf16_f32 v99, v102, v103
    v_mfma_f32_32x32x16_bf16 v[176:191], v[36:39], v[88:91], v[176:191]
    v_mul_f32 v104, s66, v104
    v_mul_f32 v105, s66, v105
    v_mul_f32 v106, s66, v106
    v_mul_f32 v107, s66, v107
    v_cvt_pk_bf16_f32 v104, v104, v105
    v_mul_f32 v108, s66, v108
    v_mul_f32 v109, s66, v109
    v_cvt_pk_bf16_f32 v105, v106, v107
    v_mul_f32 v110, s66, v110
    v_mul_f32 v111, s66, v111
    v_cvt_pk_bf16_f32 v106, v108, v109
    v_cvt_pk_bf16_f32 v107, v110, v111
    s_waitcnt lgkmcnt(2)
    v_mfma_f32_32x32x16_bf16 v[176:191], v[40:43], v[96:99], v[176:191]
    ds_read_b128 v[24:27], v6 offset:8768
    ds_read_b32 v4, v3 offset:0
    ds_read_b128 v[28:31], v7 offset:8768
    ds_read_b128 v[32:35], v6 offset:8832
    v_mov_b32 v60, 0
    v_mov_b32 v61, 0
    v_mfma_f32_32x32x16_bf16 v[176:191], v[44:47], v[104:107], v[176:191]
    ds_read_b128 v[36:39], v7 offset:8832
    v_mov_b32 v62, 0
    v_mov_b32 v63, 0
    v_mov_b32 v68, v2
    v_mov_b32 v69, v2
    s_waitcnt lgkmcnt(5)
    v_mfma_f32_32x32x16_bf16 v[192:207], v[16:19], v[48:51], 0
    ds_read_b128 v[40:43], v6 offset:8896
    v_mov_b32 v70, v2
    v_mov_b32 v71, v2
    v_lshlrev_b32 v79, 4, v1
    s_lshl_b32 s60, s3, 13
    s_add_u32 s61, s60, 94208
    v_mfma_f32_32x32x16_bf16 v[192:207], v[20:23], v[56:59], v[192:207]
    ds_read_b128 v[44:47], v7 offset:8896
    s_waitcnt lgkmcnt(5)
    v_cmp_eq_u32 vcc, 0, v4
    v_add_u32 v85, s61, v79
    s_xor_b32 s60, s60, 16384
    s_add_u32 s61, s60, 94208
    s_waitcnt lgkmcnt(4)
    v_mfma_f32_32x32x16_bf16 v[192:207], v[24:27], v[64:67], v[192:207]
    s_cbranch_vccnz L_poll20
L_pollret20:
    v_add_u32 v6, v4, v9
    v_xor_b32 v7, 32, v6
    v_mfma_f32_32x32x16_bf16 v[192:207], v[28:31], v[72:75], v[192:207]
    ds_read_b128 v[16:19], v6 offset:0
    ds_read_b128 v[20:23], v7 offset:0
    v_add_u32 v86, s61, v79
    v_lshl_add_u32 v100, v11, 9, v14
    v_add_u32 v100, 1, v100
    s_waitcnt lgkmcnt(4)
    v_mfma_f32_32x32x16_bf16 v[192:207], v[32:35], v[80:83], v[192:207]
    ds_read_b128 v[24:27], v6 offset:64
    s_lshl_b32 s60, s57, 6
    v_xor_b32 v100, s60, v100
    v_subrev_u32 v100, 1, v100
    s_lshl2_add_u32 s60, s57, 1176
    v_mov_b32 v101, s60
    v_mfma_f32_32x32x16_bf16 v[192:207], v[36:39], v[88:91], v[192:207]
    ds_read_b128 v[28:31], v7 offset:64
    v_xor_b32 v102, 4, v101
    s_lshl_b32 s68, s4, 4
    s_add_u32 s68, s68, s5
    s_mul_i32 s68, s68, 73728
    s_waitcnt lgkmcnt(4)
    v_mfma_f32_32x32x16_bf16 v[192:207], v[40:43], v[96:99], v[192:207]
    ds_read_b128 v[32:35], v6 offset:128
    s_lshl_b32 s60, s3, 11
    s_add_u32 s68, s68, s60
    v_max3_f32 v54, v176, v177, v178
    v_max3_f32 v54, v54, v179, v180
    v_max3_f32 v54, v54, v181, v182
    v_mfma_f32_32x32x16_bf16 v[192:207], v[44:47], v[104:107], v[192:207]
    ds_read_b128 v[36:39], v7 offset:128
    v_max3_f32 v54, v54, v183, v184
    v_max3_f32 v54, v54, v185, v186
    v_max3_f32 v54, v54, v187, v188
    v_max3_f32 v54, v54, v189, v190
    s_nop 6
    v_max3_f32 v55, v191, v192, v193
    v_max3_f32 v55, v55, v194, v195
    v_max3_f32 v55, v55, v196, v197
    v_max3_f32 v55, v55, v198, v199
    v_max3_f32 v55, v55, v200, v201
    v_max3_f32 v55, v55, v202, v203
    v_max3_f32 v55, v55, v204, v205
    v_max3_f32 v55, v55, v206, v207
    v_max_f32 v54, v54, v55
    v_mov_b32 v78, v54
    s_nop 1
    v_permlane32_swap_b32 v78, v54
    v_max_f32 v78, v54, v78
    v_sub_f32 v240, 0, v78
    v_sub_f32 v241, 0, v78
    v_sub_f32 v242, 0, v78
    v_sub_f32 v243, 0, v78
    v_sub_f32 v244, 0, v78
    v_sub_f32 v245, 0, v78
    v_sub_f32 v246, 0, v78
    v_sub_f32 v247, 0, v78
    v_sub_f32 v248, 0, v78
    v_sub_f32 v249, 0, v78
    v_sub_f32 v250, 0, v78
    v_sub_f32 v251, 0, v78
    v_sub_f32 v252, 0, v78
    v_sub_f32 v253, 0, v78
    v_sub_f32 v254, 0, v78
    v_sub_f32 v255, 0, v78
    s_waitcnt lgkmcnt(4)
    s_nop 0
    v_mfma_f32_32x32x16_bf16 v[208:223], v[16:19], v[48:51], v[240:255]
    ds_read_b128 v[40:43], v6 offset:192
    v_add_f32 v176, v176, v240
    v_add_f32 v177, v177, v240
    v_add_f32 v178, v178, v240
    v_add_f32 v179, v179, v240
    v_add_f32 v180, v180, v240
    v_add_f32 v181, v181, v240
    v_mfma_f32_32x32x16_bf16 v[208:223], v[20:23], v[56:59], v[208:223]
    ds_read_b128 v[44:47], v7 offset:192
    v_add_f32 v182, v182, v240
    v_add_f32 v183, v183, v240
    v_exp_f32 v176, v176
    v_exp_f32 v177, v177
    s_waitcnt lgkmcnt(4)
    v_mfma_f32_32x32x16_bf16 v[208:223], v[24:27], v[64:67], v[208:223]
    ds_read_b128 v[16:19], v6 offset:8704
    v_exp_f32 v178, v178
    v_exp_f32 v179, v179
    v_cvt_pk_bf16_f32 v176, v176, v177
    v_exp_f32 v180, v180
    v_mfma_f32_32x32x16_bf16 v[208:223], v[28:31], v[72:75], v[208:223]
    ds_read_b128 v[20:23], v7 offset:8704
    v_exp_f32 v181, v181
    v_cvt_pk_bf16_f32 v177, v178, v179
    v_exp_f32 v182, v182
    s_waitcnt lgkmcnt(4)
    v_mfma_f32_32x32x16_bf16 v[208:223], v[32:35], v[80:83], v[208:223]
    ds_read_b128 v[24:27], v6 offset:8768
    ds_read_b32 v4, v3 offset:4
    v_exp_f32 v183, v183
    v_cvt_pk_bf16_f32 v178, v180, v181
    v_cvt_pk_bf16_f32 v179, v182, v183
    v_add_f32 v184, v184, v240
    v_mfma_f32_32x32x16_bf16 v[208:223], v[36:39], v[88:91], v[208:223]
    ds_read_b128 v[28:31], v7 offset:8768
    v_add_f32 v185, v185, v240
    v_add_f32 v186, v186, v240
    v_add_f32 v187, v187, v240
    v_add_f32 v188, v188, v240
    v_add_f32 v189, v189, v240
    s_waitcnt lgkmcnt(5)
    v_mfma_f32_32x32x16_bf16 v[208:223], v[40:43], v[96:99], v[208:223]
    ds_read_b128 v[32:35], v6 offset:8832
    v_add_f32 v190, v190, v240
    v_add_f32 v191, v191, v240
    v_exp_f32 v184, v184
    v_exp_f32 v185, v185
    v_mfma_f32_32x32x16_bf16 v[208:223], v[44:47], v[104:107], v[208:223]
    ds_read_b128 v[36:39], v7 offset:8832
    v_exp_f32 v186, v186
    v_exp_f32 v187, v187
    v_cvt_pk_bf16_f32 v184, v184, v185
    s_waitcnt lgkmcnt(5)
    v_mfma_f32_32x32x16_bf16 v[224:239], v[16:19], v[48:51], v[240:255]
    ds_read_b128 v[40:43], v6 offset:8896
    v_exp_f32 v188, v188
    v_exp_f32 v189, v189
    v_cvt_pk_bf16_f32 v185, v186, v187
    v_exp_f32 v190, v190
    v_mfma_f32_32x32x16_bf16 v[224:239], v[20:23], v[56:59], v[224:239]
    ds_read_b128 v[44:47], v7 offset:8896
    s_waitcnt lgkmcnt(5)
    v_cmp_eq_u32 vcc, 0, v4
    s_cbranch_vccnz L_poll21
L_pollret21:
    s_waitcnt lgkmcnt(4)
    v_mfma_f32_32x32x16_bf16 v[224:239], v[24:27], v[64:67], v[224:239]
    v_add_u32 v52, v4, v8
    v_xor_b32 v53, 64, v52
    ds_read_b64_tr_b16 v[16:17], v52 offset:0
    ds_read_b64_tr_b16 v[18:19], v52 offset:1024
    v_exp_f32 v191, v191
    v_cvt_pk_bf16_f32 v186, v188, v189
    v_mfma_f32_32x32x16_bf16 v[224:239], v[28:31], v[72:75], v[224:239]
    ds_read_b64_tr_b16 v[20:21], v53 offset:0
    ds_read_b64_tr_b16 v[22:23], v53 offset:1024
    v_max3_f32 v54, v208, v209, v210
    v_max3_f32 v54, v54, v211, v212
    v_max3_f32 v54, v54, v213, v214
    v_max3_f32 v54, v54, v215, v216
    s_waitcnt lgkmcnt(6)
    v_mfma_f32_32x32x16_bf16 v[224:239], v[32:35], v[80:83], v[224:239]
    ds_read_b64_tr_b16 v[24:25], v52 offset:8192
    ds_read_b64_tr_b16 v[26:27], v52 offset:9216
    v_max3_f32 v54, v54, v217, v218
    v_max3_f32 v54, v54, v219, v220
    v_max3_f32 v54, v54, v221, v222
    v_cvt_pk_bf16_f32 v187, v190, v191
    v_add_f32 v192, v192, v240
    v_mfma_f32_32x32x16_bf16 v[224:239], v[36:39], v[88:91], v[224:239]
    ds_read_b64_tr_b16 v[28:29], v53 offset:8192
    ds_read_b64_tr_b16 v[30:31], v53 offset:9216
    v_add_f32 v193, v193, v240
    v_add_f32 v194, v194, v240
    v_add_f32 v195, v195, v240
    v_add_f32 v196, v196, v240
    s_waitcnt lgkmcnt(8)
    v_mfma_f32_32x32x16_bf16 v[224:239], v[40:43], v[96:99], v[224:239]
    ds_read_b64_tr_b16 v[32:33], v52 offset:2048
    ds_read_b64_tr_b16 v[34:35], v52 offset:3072
    v_add_f32 v197, v197, v240
    v_add_f32 v198, v198, v240
    v_add_f32 v199, v199, v240
    v_exp_f32 v192, v192
    v_mfma_f32_32x32x16_bf16 v[224:239], v[44:47], v[104:107], v[224:239]
    ds_read_b64_tr_b16 v[36:37], v53 offset:2048
    ds_read_b64_tr_b16 v[38:39], v53 offset:3072
    v_exp_f32 v193, v193
    v_exp_f32 v194, v194
    s_waitcnt lgkmcnt(8)
    v_mfma_f32_32x32x16_bf16 v[112:127], v[16:19], v[176:179], v[112:127]
    ds_read_b64_tr_b16 v[40:41], v52 offset:10240
    ds_read_b64_tr_b16 v[42:43], v52 offset:11264
    v_exp_f32 v195, v195
    v_cvt_pk_bf16_f32 v192, v192, v193
    v_exp_f32 v196, v196
    v_mfma_f32_16x16x32_bf16 v[60:63], v[68:71], v[176:179], v[60:63]
    v_exp_f32 v197, v197
    v_cvt_pk_bf16_f32 v193, v194, v195
    v_mfma_f32_32x32x16_bf16 v[128:143], v[20:23], v[176:179], v[128:143]
    ds_read_b64_tr_b16 v[44:45], v53 offset:10240
    ds_read_b64_tr_b16 v[46:47], v53 offset:11264
    v_exp_f32 v198, v198
    v_exp_f32 v199, v199
    s_waitcnt lgkmcnt(8)
    v_mfma_f32_32x32x16_bf16 v[144:159], v[24:27], v[176:179], v[144:159]
    ds_read_b64_tr_b16 v[16:17], v52 offset:4096
    ds_read_b64_tr_b16 v[18:19], v52 offset:5120
    v_cvt_pk_bf16_f32 v194, v196, v197
    v_cvt_pk_bf16_f32 v195, v198, v199
    v_add_f32 v200, v200, v240
    v_add_f32 v201, v201, v240
    v_add_f32 v202, v202, v240
    v_mfma_f32_32x32x16_bf16 v[160:175], v[28:31], v[176:179], v[160:175]
    ds_read_b64_tr_b16 v[20:21], v53 offset:4096
    ds_read_b64_tr_b16 v[22:23], v53 offset:5120
    v_add_f32 v203, v203, v240
    v_add_f32 v204, v204, v240
    v_add_f32 v205, v205, v240
    v_add_f32 v206, v206, v240
    v_add_f32 v207, v207, v240
    s_waitcnt lgkmcnt(8)
    v_mfma_f32_32x32x16_bf16 v[112:127], v[32:35], v[184:187], v[112:127]
    ds_read_b64_tr_b16 v[24:25], v52 offset:12288
    ds_read_b64_tr_b16 v[26:27], v52 offset:13312
    v_exp_f32 v200, v200
    v_exp_f32 v201, v201
    v_exp_f32 v202, v202
    v_mfma_f32_16x16x32_bf16 v[60:63], v[68:71], v[184:187], v[60:63]
    v_exp_f32 v203, v203
    v_cvt_pk_bf16_f32 v200, v200, v201
    v_mfma_f32_32x32x16_bf16 v[128:143], v[36:39], v[184:187], v[128:143]
    ds_read_b64_tr_b16 v[28:29], v53 offset:12288
    ds_read_b64_tr_b16 v[30:31], v53 offset:13312
    ds_read_b32 v4, v3 offset:8
    v_exp_f32 v204, v204
    v_exp_f32 v205, v205
    s_waitcnt lgkmcnt(9)
    v_mfma_f32_32x32x16_bf16 v[144:159], v[40:43], v[184:187], v[144:159]
    ds_read_b64_tr_b16 v[32:33], v52 offset:6144
    ds_read_b64_tr_b16 v[34:35], v52 offset:7168
    v_cvt_pk_bf16_f32 v201, v202, v203
    v_exp_f32 v206, v206
    v_exp_f32 v207, v207
    v_mfma_f32_32x32x16_bf16 v[160:175], v[44:47], v[184:187], v[160:175]
    ds_read_b64_tr_b16 v[36:37], v53 offset:6144
    ds_read_b64_tr_b16 v[38:39], v53 offset:7168
    v_cvt_pk_bf16_f32 v202, v204, v205
    v_cvt_pk_bf16_f32 v203, v206, v207
    v_max3_f32 v55, v223, v224, v225
    v_max3_f32 v55, v55, v226, v227
    s_waitcnt lgkmcnt(9)
    v_mfma_f32_32x32x16_bf16 v[112:127], v[16:19], v[192:195], v[112:127]
    ds_read_b64_tr_b16 v[40:41], v52 offset:14336
    ds_read_b64_tr_b16 v[42:43], v52 offset:15360
    v_max3_f32 v55, v55, v228, v229
    v_max3_f32 v55, v55, v230, v231
    v_max3_f32 v55, v55, v232, v233
    v_max3_f32 v55, v55, v234, v235
    v_max3_f32 v55, v55, v236, v237
    v_max3_f32 v55, v55, v238, v239
    v_mfma_f32_16x16x32_bf16 v[60:63], v[68:71], v[192:195], v[60:63]
    v_max_f32 v54, v54, v55
    v_cmp_lt_f32 s[62:63], s65, v54
    v_mfma_f32_32x32x16_bf16 v[128:143], v[20:23], v[192:195], v[128:143]
    ds_read_b64_tr_b16 v[44:45], v53 offset:14336
    ds_read_b64_tr_b16 v[46:47], v53 offset:15360
    s_waitcnt lgkmcnt(8)
    v_cmp_eq_u32 vcc, 0, v4
    s_cbranch_vccnz L_poll22
L_pollret22:
    v_mfma_f32_32x32x16_bf16 v[144:159], v[24:27], v[192:195], v[144:159]
    v_add_u32 v6, v4, v9
    v_xor_b32 v7, 32, v6
    ds_read_b128 v[16:19], v6 offset:0
    s_cmp_lg_u64 s[62:63], 0
    s_cbranch_scc1 L_rarei
L_rarereti:
    v_mfma_f32_32x32x16_bf16 v[160:175], v[28:31], v[192:195], v[160:175]
    ds_read_b128 v[20:23], v7 offset:0
    v_exp_f32 v208, v208
    v_exp_f32 v209, v209
    v_exp_f32 v210, v210
    s_waitcnt lgkmcnt(6)
    v_mfma_f32_32x32x16_bf16 v[112:127], v[32:35], v[200:203], v[112:127]
    ds_read_b128 v[24:27], v6 offset:64
    v_exp_f32 v211, v211
    v_cvt_pk_bf16_f32 v208, v208, v209
    v_exp_f32 v212, v212
    v_exp_f32 v213, v213
    v_mfma_f32_16x16x32_bf16 v[60:63], v[68:71], v[200:203], v[60:63]
    v_cvt_pk_bf16_f32 v209, v210, v211
    v_exp_f32 v214, v214
    v_mfma_f32_32x32x16_bf16 v[128:143], v[36:39], v[200:203], v[128:143]
    ds_read_b128 v[28:31], v7 offset:64
    v_exp_f32 v215, v215
    v_cvt_pk_bf16_f32 v210, v212, v213
    v_cvt_pk_bf16_f32 v211, v214, v215
    v_exp_f32 v216, v216
    s_waitcnt lgkmcnt(4)
    v_mfma_f32_32x32x16_bf16 v[144:159], v[40:43], v[200:203], v[144:159]
    s_barrier
    ds_read_b128 v[32:35], v6 offset:128
    v_exp_f32 v217, v217
    v_mfma_f32_32x32x16_bf16 v[160:175], v[44:47], v[200:203], v[160:175]
    ds_read_b128 v[36:39], v7 offset:128
    v_exp_f32 v218, v218
    v_exp_f32 v219, v219
L_att:
    s_waitcnt lgkmcnt(4)
    v_mfma_f32_32x32x16_bf16 v[176:191], v[16:19], v[48:51], v[240:255]
    ds_read_b128 v[40:43], v6 offset:192
    s_cmp_lg_u32 s64, 0
    s_cbranch_scc1 L_resco
L_rescreto:
    v_mfma_f32_32x32x16_bf16 v[176:191], v[20:23], v[56:59], v[176:191]
    ds_read_b128 v[44:47], v7 offset:192
    v_cvt_pk_bf16_f32 v216, v216, v217
    v_exp_f32 v220, v220
    s_waitcnt lgkmcnt(4)
    v_mfma_f32_32x32x16_bf16 v[176:191], v[24:27], v[64:67], v[176:191]
    ds_read_b128 v[16:19], v6 offset:8704
    v_exp_f32 v221, v221
    v_cvt_pk_bf16_f32 v217, v218, v219
    v_exp_f32 v222, v222
    v_mfma_f32_32x32x16_bf16 v[176:191], v[28:31], v[72:75], v[176:191]
    ds_read_b128 v[20:23], v7 offset:8704
    v_exp_f32 v223, v223
    v_cvt_pk_bf16_f32 v218, v220, v221
    v_cvt_pk_bf16_f32 v219, v222, v223
    s_waitcnt lgkmcnt(4)
    v_mfma_f32_32x32x16_bf16 v[176:191], v[32:35], v[80:83], v[176:191]
    ds_read_b128 v[24:27], v6 offset:8768
    ds_read_b32 v4, v3 offset:12
    v_exp_f32 v224, v224
    v_exp_f32 v225, v225
    v_mfma_f32_32x32x16_bf16 v[176:191], v[36:39], v[88:91], v[176:191]
    ds_read_b128 v[28:31], v7 offset:8768
    v_exp_f32 v226, v226
    v_exp_f32 v227, v227
    s_waitcnt lgkmcnt(5)
    v_mfma_f32_32x32x16_bf16 v[176:191], v[40:43], v[96:99], v[176:191]
    ds_read_b128 v[32:35], v6 offset:8832
    v_cvt_pk_bf16_f32 v224, v224, v225
    v_exp_f32 v228, v228
    v_exp_f32 v229, v229
    v_mfma_f32_32x32x16_bf16 v[176:191], v[44:47], v[104:107], v[176:191]
    ds_read_b128 v[36:39], v7 offset:8832
    v_cvt_pk_bf16_f32 v225, v226, v227
    v_exp_f32 v230, v230
    s_waitcnt lgkmcnt(5)
    v_mfma_f32_32x32x16_bf16 v[192:207], v[16:19], v[48:51], v[240:255]
    ds_read_b128 v[40:43], v6 offset:8896
    v_exp_f32 v231, v231
    v_cvt_pk_bf16_f32 v226, v228, v229
    v_cvt_pk_bf16_f32 v227, v230, v231
    v_mfma_f32_32x32x16_bf16 v[192:207], v[20:23], v[56:59], v[192:207]
    ds_read_b128 v[44:47], v7 offset:8896
    s_waitcnt lgkmcnt(5)
    v_cmp_eq_u32 vcc, 0, v4
    v_exp_f32 v232, v232
    s_waitcnt lgkmcnt(4)
    v_mfma_f32_32x32x16_bf16 v[192:207], v[24:27], v[64:67], v[192:207]
    s_cbranch_vccnz L_poll23
L_pollret23:
    v_add_u32 v52, v4, v8
    v_xor_b32 v53, 64, v52
    v_mfma_f32_32x32x16_bf16 v[192:207], v[28:31], v[72:75], v[192:207]
    ds_read_b64_tr_b16 v[16:17], v52 offset:0
    ds_read_b64_tr_b16 v[18:19], v52 offset:1024
    ds_read_b64_tr_b16 v[20:21], v53 offset:0
    ds_read_b64_tr_b16 v[22:23], v53 offset:1024
    v_max3_f32 v54, v176, v177, v178
    s_waitcnt lgkmcnt(6)
    v_mfma_f32_32x32x16_bf16 v[192:207], v[32:35], v[80:83], v[192:207]
    ds_read_b64_tr_b16 v[24:25], v52 offset:8192
    ds_read_b64_tr_b16 v[26:27], v52 offset:9216
    v_max3_f32 v54, v54, v179, v180
    v_max3_f32 v54, v54, v181, v182
    v_max3_f32 v54, v54, v183, v184
    v_max3_f32 v54, v54, v185, v186
    v_mfma_f32_32x32x16_bf16 v[192:207], v[36:39], v[88:91], v[192:207]
    ds_read_b64_tr_b16 v[28:29], v53 offset:8192
    ds_read_b64_tr_b16 v[30:31], v53 offset:9216
    v_max3_f32 v54, v54, v187, v188
    v_max3_f32 v54, v54, v189, v190
    s_waitcnt lgkmcnt(8)
    v_mfma_f32_32x32x16_bf16 v[192:207], v[40:43], v[96:99], v[192:207]
    ds_read_b64_tr_b16 v[32:33], v52 offset:2048
    ds_read_b64_tr_b16 v[34:35], v52 offset:3072
    v_exp_f32 v233, v233
    v_exp_f32 v234, v234
    v_mfma_f32_32x32x16_bf16 v[192:207], v[44:47], v[104:107], v[192:207]
    ds_read_b64_tr_b16 v[36:37], v53 offset:2048
    ds_read_b64_tr_b16 v[38:39], v53 offset:3072
    v_exp_f32 v235, v235
    v_cvt_pk_bf16_f32 v232, v232, v233
    s_waitcnt lgkmcnt(8)
    v_mfma_f32_32x32x16_bf16 v[112:127], v[16:19], v[208:211], v[112:127]
    ds_read_b64_tr_b16 v[40:41], v52 offset:10240
    ds_read_b64_tr_b16 v[42:43], v52 offset:11264
    v_exp_f32 v236, v236
    v_exp_f32 v237, v237
    v_mfma_f32_16x16x32_bf16 v[60:63], v[68:71], v[208:211], v[60:63]
    v_cvt_pk_bf16_f32 v233, v234, v235
    v_mfma_f32_32x32x16_bf16 v[128:143], v[20:23], v[208:211], v[128:143]
    ds_read_b64_tr_b16 v[44:45], v53 offset:10240
    ds_read_b64_tr_b16 v[46:47], v53 offset:11264
    v_exp_f32 v238, v238
    v_max3_f32 v55, v191, v192, v193
    s_waitcnt lgkmcnt(8)
    v_mfma_f32_32x32x16_bf16 v[144:159], v[24:27], v[208:211], v[144:159]
    ds_read_b64_tr_b16 v[16:17], v52 offset:4096
    ds_read_b64_tr_b16 v[18:19], v52 offset:5120
    v_exp_f32 v239, v239
    v_cvt_pk_bf16_f32 v234, v236, v237
    v_cvt_pk_bf16_f32 v235, v238, v239
    v_mfma_f32_32x32x16_bf16 v[160:175], v[28:31], v[208:211], v[160:175]
    ds_read_b64_tr_b16 v[20:21], v53 offset:4096
    ds_read_b64_tr_b16 v[22:23], v53 offset:5120
    v_max3_f32 v55, v55, v194, v195
    v_max3_f32 v55, v55, v196, v197
    v_max3_f32 v55, v55, v198, v199
    s_waitcnt lgkmcnt(8)
    v_mfma_f32_32x32x16_bf16 v[112:127], v[32:35], v[216:219], v[112:127]
    ds_read_b64_tr_b16 v[24:25], v52 offset:12288
    ds_read_b64_tr_b16 v[26:27], v52 offset:13312
    v_max3_f32 v55, v55, v200, v201
    v_max3_f32 v55, v55, v202, v203
    v_max3_f32 v55, v55, v204, v205
    v_max3_f32 v55, v55, v206, v207
    v_mfma_f32_16x16x32_bf16 v[60:63], v[68:71], v[216:219], v[60:63]
    v_max_f32 v54, v54, v55
    v_cmp_lt_f32 s[62:63], s65, v54
    v_mfma_f32_32x32x16_bf16 v[128:143], v[36:39], v[216:219], v[128:143]
    ds_read_b64_tr_b16 v[28:29], v53 offset:12288
    ds_read_b64_tr_b16 v[30:31], v53 offset:13312
    ds_read_b32 v4, v3 offset:16
    s_waitcnt lgkmcnt(9)
    v_mfma_f32_32x32x16_bf16 v[144:159], v[40:43], v[216:219], v[144:159]
    ds_read_b64_tr_b16 v[32:33], v52 offset:6144
    ds_read_b64_tr_b16 v[34:35], v52 offset:7168
    v_mfma_f32_32x32x16_bf16 v[160:175], v[44:47], v[216:219], v[160:175]
    ds_read_b64_tr_b16 v[36:37], v53 offset:6144
    ds_read_b64_tr_b16 v[38:39], v53 offset:7168
    s_cmp_lg_u64 s[62:63], 0
    s_cbranch_scc1 L_rareo
L_rarereto:
    s_waitcnt lgkmcnt(9)
    v_mfma_f32_32x32x16_bf16 v[112:127], v[16:19], v[224:227], v[112:127]
    ds_read_b64_tr_b16 v[40:41], v52 offset:14336
    ds_read_b64_tr_b16 v[42:43], v52 offset:15360
    v_exp_f32 v176, v176
    v_exp_f32 v177, v177
    v_mfma_f32_16x16x32_bf16 v[60:63], v[68:71], v[224:227], v[60:63]
    v_exp_f32 v178, v178
    v_mfma_f32_32x32x16_bf16 v[128:143], v[20:23], v[224:227], v[128:143]
    ds_read_b64_tr_b16 v[44:45], v53 offset:14336
    ds_read_b64_tr_b16 v[46:47], v53 offset:15360
    s_waitcnt lgkmcnt(8)
    v_cmp_eq_u32 vcc, 0, v4
    s_cbranch_vccnz L_poll24
L_pollret24:
    v_mfma_f32_32x32x16_bf16 v[144:159], v[24:27], v[224:227], v[144:159]
    v_add_u32 v6, v4, v9
    v_xor_b32 v7, 32, v6
    ds_read_b128 v[16:19], v6 offset:0
    v_exp_f32 v179, v179
    v_cvt_pk_bf16_f32 v176, v176, v177
    v_mfma_f32_32x32x16_bf16 v[160:175], v[28:31], v[224:227], v[160:175]
    ds_read_b128 v[20:23], v7 offset:0
    v_exp_f32 v180, v180
    v_exp_f32 v181, v181
    s_waitcnt lgkmcnt(6)
    v_mfma_f32_32x32x16_bf16 v[112:127], v[32:35], v[232:235], v[112:127]
    ds_read_b128 v[24:27], v6 offset:64
    v_cvt_pk_bf16_f32 v177, v178, v179
    v_exp_f32 v182, v182
    v_exp_f32 v183, v183
    v_mfma_f32_16x16x32_bf16 v[60:63], v[68:71], v[232:235], v[60:63]
    v_cvt_pk_bf16_f32 v178, v180, v181
    v_cvt_pk_bf16_f32 v179, v182, v183
    v_mfma_f32_32x32x16_bf16 v[128:143], v[36:39], v[232:235], v[128:143]
    ds_read_b128 v[28:31], v7 offset:64
    v_exp_f32 v184, v184
    v_exp_f32 v185, v185
    s_waitcnt lgkmcnt(4)
    v_mfma_f32_32x32x16_bf16 v[144:159], v[40:43], v[232:235], v[144:159]
    s_barrier
    ds_read_b128 v[32:35], v6 offset:128
    v_mfma_f32_32x32x16_bf16 v[160:175], v[44:47], v[232:235], v[160:175]
    ds_read_b128 v[36:39], v7 offset:128
    v_exp_f32 v186, v186
    v_exp_f32 v187, v187
    s_waitcnt lgkmcnt(4)
    v_mfma_f32_32x32x16_bf16 v[208:223], v[16:19], v[48:51], v[240:255]
    ds_read_b128 v[40:43], v6 offset:192
    s_cmp_lg_u32 s64, 0
    s_cbranch_scc1 L_resce
L_rescrete:
    v_mfma_f32_32x32x16_bf16 v[208:223], v[20:23], v[56:59], v[208:223]
    ds_read_b128 v[44:47], v7 offset:192
    v_cvt_pk_bf16_f32 v184, v184, v185
    v_exp_f32 v188, v188
    s_waitcnt lgkmcnt(4)
    v_mfma_f32_32x32x16_bf16 v[208:223], v[24:27], v[64:67], v[208:223]
    ds_read_b128 v[16:19], v6 offset:8704
    v_exp_f32 v189, v189
    v_cvt_pk_bf16_f32 v185, v186, v187
    v_exp_f32 v190, v190
    v_mfma_f32_32x32x16_bf16 v[208:223], v[28:31], v[72:75], v[208:223]
    ds_read_b128 v[20:23], v7 offset:8704
    v_exp_f32 v191, v191
    v_cvt_pk_bf16_f32 v186, v188, v189
    v_cvt_pk_bf16_f32 v187, v190, v191
    s_waitcnt lgkmcnt(4)
    v_mfma_f32_32x32x16_bf16 v[208:223], v[32:35], v[80:83], v[208:223]
    ds_read_b128 v[24:27], v6 offset:8768
    ds_read_b32 v4, v3 offset:20
    v_exp_f32 v192, v192
    v_exp_f32 v193, v193
    v_mfma_f32_32x32x16_bf16 v[208:223], v[36:39], v[88:91], v[208:223]
    ds_read_b128 v[28:31], v7 offset:8768
    v_exp_f32 v194, v194
    v_exp_f32 v195, v195
    s_waitcnt lgkmcnt(5)
    v_mfma_f32_32x32x16_bf16 v[208:223], v[40:43], v[96:99], v[208:223]
    ds_read_b128 v[32:35], v6 offset:8832
    v_cvt_pk_bf16_f32 v192, v192, v193
    v_exp_f32 v196, v196
    v_exp_f32 v197, v197
    v_mfma_f32_32x32x16_bf16 v[208:223], v[44:47], v[104:107], v[208:223]
    ds_read_b128 v[36:39], v7 offset:8832
    v_cvt_pk_bf16_f32 v193, v194, v195
    v_exp_f32 v198, v198
    s_waitcnt lgkmcnt(5)
    v_mfma_f32_32x32x16_bf16 v[224:239], v[16:19], v[48:51], v[240:255]
    ds_read_b128 v[40:43], v6 offset:8896
    v_exp_f32 v199, v199
    v_cvt_pk_bf16_f32 v194, v196, v197
    v_cvt_pk_bf16_f32 v195, v198, v199
    v_mfma_f32_32x32x16_bf16 v[224:239], v[20:23], v[56:59], v[224:239]
    ds_read_b128 v[44:47], v7 offset:8896
    s_waitcnt lgkmcnt(5)
    v_cmp_eq_u32 vcc, 0, v4
    v_exp_f32 v200, v200
    s_waitcnt lgkmcnt(4)
    v_mfma_f32_32x32x16_bf16 v[224:239], v[24:27], v[64:67], v[224:239]
    s_cbranch_vccnz L_poll25
L_pollret25:
    v_add_u32 v52, v4, v8
    v_xor_b32 v53, 64, v52
    v_mfma_f32_32x32x16_bf16 v[224:239], v[28:31], v[72:75], v[224:239]
    ds_read_b64_tr_b16 v[16:17], v52 offset:0
    ds_read_b64_tr_b16 v[18:19], v52 offset:1024
    ds_read_b64_tr_b16 v[20:21], v53 offset:0
    ds_read_b64_tr_b16 v[22:23], v53 offset:1024
    v_max3_f32 v54, v208, v209, v210
    s_waitcnt lgkmcnt(6)
    v_mfma_f32_32x32x16_bf16 v[224:239], v[32:35], v[80:83], v[224:239]
    ds_read_b64_tr_b16 v[24:25], v52 offset:8192
    ds_read_b64_tr_b16 v[26:27], v52 offset:9216
    v_max3_f32 v54, v54, v211, v212
    v_max3_f32 v54, v54, v213, v214
    v_max3_f32 v54, v54, v215, v216
    v_max3_f32 v54, v54, v217, v218
    v_mfma_f32_32x32x16_bf16 v[224:239], v[36:39], v[88:91], v[224:239]
    ds_read_b64_tr_b16 v[28:29], v53 offset:8192
    ds_read_b64_tr_b16 v[30:31], v53 offset:9216
    v_max3_f32 v54, v54, v219, v220
    v_max3_f32 v54, v54, v221, v222
    s_waitcnt lgkmcnt(8)
    v_mfma_f32_32x32x16_bf16 v[224:239], v[40:43], v[96:99], v[224:239]
    ds_read_b64_tr_b16 v[32:33], v52 offset:2048
    ds_read_b64_tr_b16 v[34:35], v52 offset:3072
    v_exp_f32 v201, v201
    v_exp_f32 v202, v202
    v_mfma_f32_32x32x16_bf16 v[224:239], v[44:47], v[104:107], v[224:239]
    ds_read_b64_tr_b16 v[36:37], v53 offset:2048
    ds_read_b64_tr_b16 v[38:39], v53 offset:3072
    v_exp_f32 v203, v203
    v_cvt_pk_bf16_f32 v200, v200, v201
    s_waitcnt lgkmcnt(8)
    v_mfma_f32_32x32x16_bf16 v[112:127], v[16:19], v[176:179], v[112:127]
    ds_read_b64_tr_b16 v[40:41], v52 offset:10240
    ds_read_b64_tr_b16 v[42:43], v52 offset:11264
    v_exp_f32 v204, v204
    v_exp_f32 v205, v205
    v_mfma_f32_16x16x32_bf16 v[60:63], v[68:71], v[176:179], v[60:63]
    v_cvt_pk_bf16_f32 v201, v202, v203
    v_mfma_f32_32x32x16_bf16 v[128:143], v[20:23], v[176:179], v[128:143]
    ds_read_b64_tr_b16 v[44:45], v53 offset:10240
    ds_read_b64_tr_b16 v[46:47], v53 offset:11264
    v_exp_f32 v206, v206
    v_max3_f32 v55, v223, v224, v225
    s_waitcnt lgkmcnt(8)
    v_mfma_f32_32x32x16_bf16 v[144:159], v[24:27], v[176:179], v[144:159]
    ds_read_b64_tr_b16 v[16:17], v52 offset:4096
    ds_read_b64_tr_b16 v[18:19], v52 offset:5120
    v_exp_f32 v207, v207
    v_cvt_pk_bf16_f32 v202, v204, v205
    v_cvt_pk_bf16_f32 v203, v206, v207
    v_mfma_f32_32x32x16_bf16 v[160:175], v[28:31], v[176:179], v[160:175]
    ds_read_b64_tr_b16 v[20:21], v53 offset:4096
    ds_read_b64_tr_b16 v[22:23], v53 offset:5120
    v_max3_f32 v55, v55, v226, v227
    v_max3_f32 v55, v55, v228, v229
    v_max3_f32 v55, v55, v230, v231
    s_waitcnt lgkmcnt(8)
    v_mfma_f32_32x32x16_bf16 v[112:127], v[32:35], v[184:187], v[112:127]
    ds_read_b64_tr_b16 v[24:25], v52 offset:12288
    ds_read_b64_tr_b16 v[26:27], v52 offset:13312
    v_max3_f32 v55, v55, v232, v233
    v_max3_f32 v55, v55, v234, v235
    v_max3_f32 v55, v55, v236, v237
    v_max3_f32 v55, v55, v238, v239
    v_mfma_f32_16x16x32_bf16 v[60:63], v[68:71], v[184:187], v[60:63]
    v_max_f32 v54, v54, v55
    v_cmp_lt_f32 s[62:63], s65, v54
    v_mfma_f32_32x32x16_bf16 v[128:143], v[36:39], v[184:187], v[128:143]
    ds_read_b64_tr_b16 v[28:29], v53 offset:12288
    ds_read_b64_tr_b16 v[30:31], v53 offset:13312
    ds_read_b32 v4, v3 offset:24
    s_waitcnt lgkmcnt(9)
    v_mfma_f32_32x32x16_bf16 v[144:159], v[40:43], v[184:187], v[144:159]
    ds_read_b64_tr_b16 v[32:33], v52 offset:6144
    ds_read_b64_tr_b16 v[34:35], v52 offset:7168
    s_cmp_lg_u64 s[62:63], 0
    s_cbranch_scc1 L_raree
L_rarerete:
    v_mfma_f32_32x32x16_bf16 v[160:175], v[44:47], v[184:187], v[160:175]
    ds_read_b64_tr_b16 v[36:37], v53 offset:6144
    ds_read_b64_tr_b16 v[38:39], v53 offset:7168
    v_exp_f32 v208, v208
    s_waitcnt lgkmcnt(9)
    v_mfma_f32_32x32x16_bf16 v[112:127], v[16:19], v[192:195], v[112:127]
    ds_read_b64_tr_b16 v[40:41], v52 offset:14336
    ds_read_b64_tr_b16 v[42:43], v52 offset:15360
    v_exp_f32 v209, v209
    v_exp_f32 v210, v210
    v_mfma_f32_16x16x32_bf16 v[60:63], v[68:71], v[192:195], v[60:63]
    v_exp_f32 v211, v211
    v_mfma_f32_32x32x16_bf16 v[128:143], v[20:23], v[192:195], v[128:143]
    ds_read_b64_tr_b16 v[44:45], v53 offset:14336
    ds_read_b64_tr_b16 v[46:47], v53 offset:15360
    s_waitcnt lgkmcnt(8)
    v_cmp_eq_u32 vcc, 0, v4
    s_cbranch_vccnz L_poll26
L_pollret26:
    v_mfma_f32_32x32x16_bf16 v[144:159], v[24:27], v[192:195], v[144:159]
    v_add_u32 v6, v4, v9
    v_xor_b32 v7, 32, v6
    ds_read_b128 v[16:19], v6 offset:0
    v_cvt_pk_bf16_f32 v208, v208, v209
    v_exp_f32 v212, v212
    v_mfma_f32_32x32x16_bf16 v[160:175], v[28:31], v[192:195], v[160:175]
    ds_read_b128 v[20:23], v7 offset:0
    v_exp_f32 v213, v213
    v_cvt_pk_bf16_f32 v209, v210, v211
    s_waitcnt lgkmcnt(6)
    v_mfma_f32_32x32x16_bf16 v[112:127], v[32:35], v[200:203], v[112:127]
    ds_read_b128 v[24:27], v6 offset:64
    v_exp_f32 v214, v214
    v_exp_f32 v215, v215
    v_cvt_pk_bf16_f32 v210, v212, v213
    v_mfma_f32_16x16x32_bf16 v[60:63], v[68:71], v[200:203], v[60:63]
    s_add_u32 s59, s59, 1
    v_cvt_pk_bf16_f32 v211, v214, v215
    v_mfma_f32_32x32x16_bf16 v[128:143], v[36:39], v[200:203], v[128:143]
    ds_read_b128 v[28:31], v7 offset:64
    v_exp_f32 v216, v216
    v_exp_f32 v217, v217
    s_waitcnt lgkmcnt(4)
    v_mfma_f32_32x32x16_bf16 v[144:159], v[40:43], v[200:203], v[144:159]
    s_barrier
    ds_read_b128 v[32:35], v6 offset:128
    v_mfma_f32_32x32x16_bf16 v[160:175], v[44:47], v[200:203], v[160:175]
    ds_read_b128 v[36:39], v7 offset:128
    v_exp_f32 v218, v218
    v_exp_f32 v219, v219
    v_add_u32 v3, 16, v3
    s_cmp_lt_u32 s59, 3
    s_cbranch_scc1 L_att
L_fin:
    v_add_u32 v52, v4, v8
    v_xor_b32 v53, 64, v52
    s_waitcnt lgkmcnt(5)
    ds_read_b64_tr_b16 v[16:17], v52 offset:0
    ds_read_b64_tr_b16 v[18:19], v52 offset:1024
    s_waitcnt lgkmcnt(6)
    ds_read_b64_tr_b16 v[20:21], v53 offset:0
    ds_read_b64_tr_b16 v[22:23], v53 offset:1024
    s_waitcnt lgkmcnt(7)
    ds_read_b64_tr_b16 v[24:25], v52 offset:8192
    ds_read_b64_tr_b16 v[26:27], v52 offset:9216
    s_waitcnt lgkmcnt(8)
    ds_read_b64_tr_b16 v[28:29], v53 offset:8192
    ds_read_b64_tr_b16 v[30:31], v53 offset:9216
    s_waitcnt lgkmcnt(9)
    ds_read_b64_tr_b16 v[32:33], v52 offset:2048
    ds_read_b64_tr_b16 v[34:35], v52 offset:3072
    s_waitcnt lgkmcnt(10)
    ds_read_b64_tr_b16 v[36:37], v53 offset:2048
    ds_read_b64_tr_b16 v[38:39], v53 offset:3072
    s_cmp_lg_u32 s64, 0
    s_cbranch_scc1 L_rescf
L_rescretf:
    v_cvt_pk_bf16_f32 v216, v216, v217
    v_exp_f32 v220, v220
    v_exp_f32 v221, v221
    v_cvt_pk_bf16_f32 v217, v218, v219
    v_exp_f32 v222, v222
    v_exp_f32 v223, v223
    v_cvt_pk_bf16_f32 v218, v220, v221
    v_cvt_pk_bf16_f32 v219, v222, v223
L_ol:
    s_waitcnt lgkmcnt(8)
    v_mfma_f32_32x32x16_bf16 v[112:127], v[16:19], v[208:211], v[112:127]
    ds_read_b64_tr_b16 v[40:41], v52 offset:10240
    ds_read_b64_tr_b16 v[42:43], v52 offset:11264
    v_exp_f32 v224, v224
    v_exp_f32 v225, v225
    v_mfma_f32_16x16x32_bf16 v[60:63], v[68:71], v[208:211], v[60:63]
    v_exp_f32 v226, v226
    v_mfma_f32_32x32x16_bf16 v[128:143], v[20:23], v[208:211], v[128:143]
    ds_read_b64_tr_b16 v[44:45], v53 offset:10240
    ds_read_b64_tr_b16 v[46:47], v53 offset:11264
    v_exp_f32 v227, v227
    v_cvt_pk_bf16_f32 v224, v224, v225
    s_waitcnt lgkmcnt(8)
    v_mfma_f32_32x32x16_bf16 v[144:159], v[24:27], v[208:211], v[144:159]
    ds_read_b64_tr_b16 v[16:17], v52 offset:4096
    ds_read_b64_tr_b16 v[18:19], v52 offset:5120
    v_exp_f32 v228, v228
    v_exp_f32 v229, v229
    v_mfma_f32_16x16x32_bf16 v[60:63], v[68:71], v[216:219], v[60:63]
    v_cvt_pk_bf16_f32 v225, v226, v227
    v_mfma_f32_32x32x16_bf16 v[160:175], v[28:31], v[208:211], v[160:175]
    ds_read_b64_tr_b16 v[20:21], v52 offset:6144
    ds_read_b64_tr_b16 v[22:23], v52 offset:7168
    v_exp_f32 v230, v230
    s_waitcnt lgkmcnt(8)
    v_mfma_f32_32x32x16_bf16 v[112:127], v[32:35], v[216:219], v[112:127]
    v_exp_f32 v231, v231
    v_cvt_pk_bf16_f32 v226, v228, v229
    v_cvt_pk_bf16_f32 v227, v230, v231
    ds_read_b64_tr_b16 v[24:25], v53 offset:4096
    ds_read_b64_tr_b16 v[26:27], v53 offset:5120
    v_mfma_f32_32x32x16_bf16 v[128:143], v[36:39], v[216:219], v[128:143]
    ds_read_b64_tr_b16 v[28:29], v53 offset:6144
    ds_read_b64_tr_b16 v[30:31], v53 offset:7168
    ds_read_b32 v84, v101 offset:0
    v_exp_f32 v232, v232
    s_waitcnt lgkmcnt(9)
    v_mfma_f32_32x32x16_bf16 v[144:159], v[40:43], v[216:219], v[144:159]
    v_exp_f32 v233, v233
    v_exp_f32 v234, v234
    v_exp_f32 v235, v235
    v_mfma_f32_16x16x32_bf16 v[60:63], v[68:71], v[224:227], v[60:63]
    v_cvt_pk_bf16_f32 v232, v232, v233
    v_mfma_f32_32x32x16_bf16 v[160:175], v[44:47], v[216:219], v[160:175]
    v_exp_f32 v236, v236
    v_exp_f32 v237, v237
    v_cvt_pk_bf16_f32 v233, v234, v235
    v_exp_f32 v238, v238
    v_exp_f32 v239, v239
    v_cvt_pk_bf16_f32 v234, v236, v237
    v_cvt_pk_bf16_f32 v235, v238, v239
    s_waitcnt lgkmcnt(5)
    v_mfma_f32_32x32x16_bf16 v[112:127], v[16:19], v[224:227], v[112:127]
    ds_read_b64_tr_b16 v[32:33], v52 offset:12288
    ds_read_b64_tr_b16 v[34:35], v52 offset:13312
    ds_read_b64_tr_b16 v[36:37], v52 offset:14336
    ds_read_b64_tr_b16 v[38:39], v52 offset:15360
    ds_read_b64_tr_b16 v[40:41], v53 offset:12288
    ds_read_b64_tr_b16 v[42:43], v53 offset:13312
    v_mfma_f32_16x16x32_bf16 v[60:63], v[68:71], v[232:235], v[60:63]
    v_mfma_f32_32x32x16_bf16 v[112:127], v[20:23], v[232:235], v[112:127]
    ds_read_b64_tr_b16 v[44:45], v53 offset:14336
    ds_read_b64_tr_b16 v[46:47], v53 offset:15360
    s_waitcnt lgkmcnt(8)
    v_cmp_eq_u32 vcc, 0, v84
    v_mfma_f32_32x32x16_bf16 v[128:143], v[24:27], v[224:227], v[128:143]
    s_nop 1
    v_rcp_f32 v76, v60
    s_cbranch_vccnz L_poll27
L_pollret27:
    v_mfma_f32_32x32x16_bf16 v[128:143], v[28:31], v[232:235], v[128:143]
    v_add_u32 v6, v84, v100
    ds_read_b64_tr_b16 v[16:17], v6 offset:0
    ds_read_b64_tr_b16 v[18:19], v6 offset:1024
    ds_read_b64_tr_b16 v[20:21], v6 offset:2048
    ds_read_b64_tr_b16 v[22:23], v6 offset:3072
    s_waitcnt lgkmcnt(8)
    v_mfma_f32_32x32x16_bf16 v[144:159], v[32:35], v[224:227], v[144:159]
    ds_read_b64_tr_b16 v[24:25], v6 offset:4096
    ds_read_b64_tr_b16 v[26:27], v6 offset:5120
    v_mul_f32 v112, v76, v112
    v_mul_f32 v113, v76, v113
    v_mul_f32 v114, v76, v114
    v_mul_f32 v115, v76, v115
    v_mfma_f32_32x32x16_bf16 v[144:159], v[36:39], v[232:235], v[144:159]
    ds_read_b64_tr_b16 v[28:29], v6 offset:6144
    ds_read_b64_tr_b16 v[30:31], v6 offset:7168
    ds_read_b32 v4, v101 offset:8
    v_cvt_pk_bf16_f32 v112, v112, v113
    v_mul_f32 v116, v76, v116
    s_waitcnt lgkmcnt(9)
    v_mfma_f32_32x32x16_bf16 v[160:175], v[40:43], v[224:227], v[160:175]
    v_mul_f32 v117, v76, v117
    v_cvt_pk_bf16_f32 v113, v114, v115
    v_mul_f32 v118, v76, v118
    v_mul_f32 v119, v76, v119
    v_cvt_pk_bf16_f32 v114, v116, v117
    v_cvt_pk_bf16_f32 v115, v118, v119
    v_mfma_f32_32x32x16_bf16 v[160:175], v[44:47], v[232:235], v[160:175]
    ds_write_b128 v85, v[112:115] offset:0
    v_mul_f32 v120, v76, v120
    v_mul_f32 v121, v76, v121
    v_mul_f32 v122, v76, v122
    v_mul_f32 v123, v76, v123
    v_cvt_pk_bf16_f32 v120, v120, v121
    v_mul_f32 v124, v76, v124
    v_mul_f32 v125, v76, v125
    v_cvt_pk_bf16_f32 v121, v122, v123
    v_mul_f32 v126, v76, v126
    v_mul_f32 v127, v76, v127
    v_cvt_pk_bf16_f32 v122, v124, v125
    v_cvt_pk_bf16_f32 v123, v126, v127
    s_waitcnt lgkmcnt(6)
    v_mfma_f32_32x32x16_bf16 v[208:223], v[16:19], v[112:115], 0
    ds_read_b64_tr_b16 v[32:33], v6 offset:8192
    ds_read_b64_tr_b16 v[34:35], v6 offset:9216
    ds_read_b64_tr_b16 v[36:37], v6 offset:10240
    ds_read_b64_tr_b16 v[38:39], v6 offset:11264
    ds_write_b128 v85, v[120:123] offset:1024
    v_mul_f32 v128, v76, v128
    v_mul_f32 v129, v76, v129
    v_mul_f32 v130, v76, v130
    v_mul_f32 v131, v76, v131
    v_cvt_pk_bf16_f32 v128, v128, v129
    v_mul_f32 v132, v76, v132
    v_mul_f32 v133, v76, v133
    v_cvt_pk_bf16_f32 v129, v130, v131
    v_mul_f32 v134, v76, v134
    v_mul_f32 v135, v76, v135
    v_cvt_pk_bf16_f32 v130, v132, v133
    v_cvt_pk_bf16_f32 v131, v134, v135
    v_mfma_f32_32x32x16_bf16 v[208:223], v[20:23], v[120:123], v[208:223]
    ds_write_b128 v85, v[128:131] offset:2048
    v_mul_f32 v136, v76, v136
    v_mul_f32 v137, v76, v137
    v_mul_f32 v138, v76, v138
    v_mul_f32 v139, v76, v139
    v_cvt_pk_bf16_f32 v136, v136, v137
    v_mul_f32 v140, v76, v140
    v_mul_f32 v141, v76, v141
    v_cvt_pk_bf16_f32 v137, v138, v139
    v_mul_f32 v142, v76, v142
    v_mul_f32 v143, v76, v143
    v_cvt_pk_bf16_f32 v138, v140, v141
    v_cvt_pk_bf16_f32 v139, v142, v143
    s_waitcnt lgkmcnt(8)
    v_mfma_f32_32x32x16_bf16 v[208:223], v[24:27], v[128:131], v[208:223]
    ds_read_b64_tr_b16 v[40:41], v6 offset:12288
    ds_read_b64_tr_b16 v[42:43], v6 offset:13312
    ds_read_b64_tr_b16 v[44:45], v6 offset:14336
    ds_read_b64_tr_b16 v[46:47], v6 offset:15360
    ds_write_b128 v85, v[136:139] offset:3072
    v_mul_f32 v144, v76, v144
    v_mul_f32 v145, v76, v145
    v_mul_f32 v146, v76, v146
    v_mul_f32 v147, v76, v147
    v_cvt_pk_bf16_f32 v144, v144, v145
    v_mul_f32 v148, v76, v148
    v_mul_f32 v149, v76, v149
    v_cvt_pk_bf16_f32 v145, v146, v147
    v_mul_f32 v150, v76, v150
    v_mul_f32 v151, v76, v151
    v_cvt_pk_bf16_f32 v146, v148, v149
    v_cvt_pk_bf16_f32 v147, v150, v151
    v_mfma_f32_32x32x16_bf16 v[208:223], v[28:31], v[136:139], v[208:223]
    s_waitcnt lgkmcnt(12)
    v_cmp_eq_u32 vcc, 0, v4
    ds_write_b128 v85, v[144:147] offset:4096
    v_mul_f32 v152, v76, v152
    v_mul_f32 v153, v76, v153
    v_mul_f32 v154, v76, v154
    v_mul_f32 v155, v76, v155
    v_cvt_pk_bf16_f32 v152, v152, v153
    v_mul_f32 v156, v76, v156
    v_mul_f32 v157, v76, v157
    v_cvt_pk_bf16_f32 v153, v154, v155
    v_mul_f32 v158, v76, v158
    v_mul_f32 v159, v76, v159
    v_cvt_pk_bf16_f32 v154, v156, v157
    v_cvt_pk_bf16_f32 v155, v158, v159
    s_waitcnt lgkmcnt(8)
    v_mfma_f32_32x32x16_bf16 v[208:223], v[32:35], v[144:147], v[208:223]
    s_cbranch_vccnz L_poll28
L_pollret28:
    v_add_u32 v7, v4, v100
    ds_read_b64_tr_b16 v[16:17], v7 offset:0
    ds_read_b64_tr_b16 v[18:19], v7 offset:1024
    ds_read_b64_tr_b16 v[20:21], v7 offset:2048
    ds_read_b64_tr_b16 v[22:23], v7 offset:3072
    ds_write_b128 v85, v[152:155] offset:5120
    v_mul_f32 v160, v76, v160
    v_mul_f32 v161, v76, v161
    v_mul_f32 v162, v76, v162
    v_mul_f32 v163, v76, v163
    v_cvt_pk_bf16_f32 v160, v160, v161
    v_mul_f32 v164, v76, v164
    v_mul_f32 v165, v76, v165
    v_cvt_pk_bf16_f32 v161, v162, v163
    v_mul_f32 v166, v76, v166
    v_mul_f32 v167, v76, v167
    v_cvt_pk_bf16_f32 v162, v164, v165
    v_cvt_pk_bf16_f32 v163, v166, v167
    v_mfma_f32_32x32x16_bf16 v[208:223], v[36:39], v[152:155], v[208:223]
    ds_write_b128 v85, v[160:163] offset:6144
    v_mul_f32 v168, v76, v168
    v_mul_f32 v169, v76, v169
    v_mul_f32 v170, v76, v170
    v_mul_f32 v171, v76, v171
    v_cvt_pk_bf16_f32 v168, v168, v169
    v_mul_f32 v172, v76, v172
    v_mul_f32 v173, v76, v173
    v_cvt_pk_bf16_f32 v169, v170, v171
    v_mul_f32 v174, v76, v174
    v_mul_f32 v175, v76, v175
    v_cvt_pk_bf16_f32 v170, v172, v173
    v_cvt_pk_bf16_f32 v171, v174, v175
    s_waitcnt lgkmcnt(8)
    v_mfma_f32_32x32x16_bf16 v[208:223], v[40:43], v[160:163], v[208:223]
    ds_read_b64_tr_b16 v[24:25], v7 offset:4096
    ds_read_b64_tr_b16 v[26:27], v7 offset:5120
    ds_read_b64_tr_b16 v[28:29], v7 offset:6144
    ds_read_b64_tr_b16 v[30:31], v7 offset:7168
    ds_read_b32 v84, v102 offset:0
    ds_write_b128 v85, v[168:171] offset:7168
    v_mfma_f32_32x32x16_bf16 v[208:223], v[44:47], v[168:171], v[208:223]
    ds_read_b64_tr_b16 v[32:33], v7 offset:8192
    s_waitcnt lgkmcnt(14)
    ds_read_b64_tr_b16 v[34:35], v7 offset:9216
    s_waitcnt lgkmcnt(14)
    ds_read_b64_tr_b16 v[36:37], v7 offset:10240
    s_waitcnt lgkmcnt(14)
    ds_read_b64_tr_b16 v[38:39], v7 offset:11264
    s_waitcnt lgkmcnt(12)
    v_mfma_f32_32x32x16_bf16 v[224:239], v[16:19], v[112:115], 0
    s_waitcnt lgkmcnt(4)
    s_barrier
    ds_read_b128 v[176:179], v86 offset:0
    v_mfma_f32_32x32x16_bf16 v[224:239], v[20:23], v[120:123], v[224:239]
    ds_read_b128 v[180:183], v86 offset:1024
    ds_read_b64_tr_b16 v[40:41], v7 offset:12288
    ds_read_b64_tr_b16 v[42:43], v7 offset:13312
    ds_read_b64_tr_b16 v[44:45], v7 offset:14336
    ds_read_b64_tr_b16 v[46:47], v7 offset:15360
    v_mfma_f32_32x32x16_bf16 v[224:239], v[24:27], v[128:131], v[224:239]
    ds_read_b128 v[184:187], v86 offset:2048
    ds_read_b128 v[188:191], v86 offset:3072
    v_cmp_eq_u32 vcc, 0, v84
    ds_read_b128 v[192:195], v86 offset:4096
    ds_read_b128 v[196:199], v86 offset:5120
    ds_read_b128 v[200:203], v86 offset:6144
    v_mfma_f32_32x32x16_bf16 v[224:239], v[28:31], v[136:139], v[224:239]
    s_cbranch_vccnz L_poll29
L_pollret29:
    v_add_u32 v6, v84, v100
    s_waitcnt lgkmcnt(11)
    v_mfma_f32_32x32x16_bf16 v[224:239], v[32:35], v[144:147], v[224:239]
    ds_read_b64_tr_b16 v[16:17], v6 offset:0
    ds_read_b64_tr_b16 v[18:19], v6 offset:1024
    ds_read_b64_tr_b16 v[20:21], v6 offset:2048
    ds_read_b64_tr_b16 v[22:23], v6 offset:3072
    s_waitcnt lgkmcnt(14)
    ds_read_b128 v[204:207], v86 offset:7168
    v_mfma_f32_32x32x16_bf16 v[224:239], v[36:39], v[152:155], v[224:239]
    s_waitcnt lgkmcnt(14)
    ds_read_b64_tr_b16 v[24:25], v6 offset:4096
    s_waitcnt lgkmcnt(14)
    ds_read_b64_tr_b16 v[26:27], v6 offset:5120
    s_waitcnt lgkmcnt(14)
    ds_read_b64_tr_b16 v[28:29], v6 offset:6144
    s_waitcnt lgkmcnt(14)
    ds_read_b64_tr_b16 v[30:31], v6 offset:7168
    s_waitcnt lgkmcnt(14)
    ds_read_b32 v4, v102 offset:8
    v_mfma_f32_32x32x16_bf16 v[224:239], v[40:43], v[160:163], v[224:239]
    s_waitcnt lgkmcnt(14)
    ds_read_b64_tr_b16 v[32:33], v6 offset:8192
    s_waitcnt lgkmcnt(14)
    ds_read_b64_tr_b16 v[34:35], v6 offset:9216
    v_mfma_f32_32x32x16_bf16 v[224:239], v[44:47], v[168:171], v[224:239]
    s_waitcnt lgkmcnt(14)
    ds_read_b64_tr_b16 v[36:37], v6 offset:10240
    s_waitcnt lgkmcnt(14)
    ds_read_b64_tr_b16 v[38:39], v6 offset:11264
    s_waitcnt lgkmcnt(10)
    v_mfma_f32_32x32x16_bf16 v[208:223], v[16:19], v[176:179], v[208:223]
    s_waitcnt lgkmcnt(9)
    s_barrier
    v_mfma_f32_32x32x16_bf16 v[208:223], v[20:23], v[180:183], v[208:223]
    ds_read_b64_tr_b16 v[40:41], v6 offset:12288
    ds_read_b64_tr_b16 v[42:43], v6 offset:13312
    ds_read_b64_tr_b16 v[44:45], v6 offset:14336
    ds_read_b64_tr_b16 v[46:47], v6 offset:15360
    s_waitcnt lgkmcnt(8)
    v_cmp_eq_u32 vcc, 0, v4
    v_mfma_f32_32x32x16_bf16 v[208:223], v[24:27], v[184:187], v[208:223]
    s_cbranch_vccnz L_poll30
L_pollret30:
    v_add_u32 v7, v4, v100
    v_mfma_f32_32x32x16_bf16 v[208:223], v[28:31], v[188:191], v[208:223]
    ds_read_b64_tr_b16 v[16:17], v7 offset:0
    ds_read_b64_tr_b16 v[18:19], v7 offset:1024
    ds_read_b64_tr_b16 v[20:21], v7 offset:2048
    ds_read_b64_tr_b16 v[22:23], v7 offset:3072
    s_waitcnt lgkmcnt(8)
    v_mfma_f32_32x32x16_bf16 v[208:223], v[32:35], v[192:195], v[208:223]
    ds_read_b64_tr_b16 v[24:25], v7 offset:4096
    ds_read_b64_tr_b16 v[26:27], v7 offset:5120
    v_mfma_f32_32x32x16_bf16 v[208:223], v[36:39], v[196:199], v[208:223]
    ds_read_b64_tr_b16 v[28:29], v7 offset:6144
    ds_read_b64_tr_b16 v[30:31], v7 offset:7168
    ds_read_b32 v84, v101 offset:16
    s_waitcnt lgkmcnt(9)
    v_mfma_f32_32x32x16_bf16 v[208:223], v[40:43], v[200:203], v[208:223]
    ds_read_b64_tr_b16 v[32:33], v7 offset:8192
    ds_read_b64_tr_b16 v[34:35], v7 offset:9216
    v_mfma_f32_32x32x16_bf16 v[208:223], v[44:47], v[204:207], v[208:223]
    ds_read_b64_tr_b16 v[36:37], v7 offset:10240
    ds_read_b64_tr_b16 v[38:39], v7 offset:11264
    s_waitcnt lgkmcnt(9)
    v_mfma_f32_32x32x16_bf16 v[224:239], v[16:19], v[176:179], v[224:239]
    ds_read_b64_tr_b16 v[40:41], v7 offset:12288
    ds_read_b64_tr_b16 v[42:43], v7 offset:13312
    v_mfma_f32_32x32x16_bf16 v[224:239], v[20:23], v[180:183], v[224:239]
    ds_read_b64_tr_b16 v[44:45], v7 offset:14336
    ds_read_b64_tr_b16 v[46:47], v7 offset:15360
    s_waitcnt lgkmcnt(8)
    v_cmp_eq_u32 vcc, 0, v84
    v_mfma_f32_32x32x16_bf16 v[224:239], v[24:27], v[184:187], v[224:239]
    s_cbranch_vccnz L_poll31
L_pollret31:
    v_add_u32 v6, v84, v100
    v_cvt_pk_bf16_f32 v240, v208, v209
    v_mfma_f32_32x32x16_bf16 v[224:239], v[28:31], v[188:191], v[224:239]
    ds_read_b64_tr_b16 v[16:17], v6 offset:0
    ds_read_b64_tr_b16 v[18:19], v6 offset:1024
    ds_read_b64_tr_b16 v[20:21], v6 offset:2048
    ds_read_b64_tr_b16 v[22:23], v6 offset:3072
    v_cvt_pk_bf16_f32 v241, v210, v211
    s_waitcnt lgkmcnt(8)
    v_mfma_f32_32x32x16_bf16 v[224:239], v[32:35], v[192:195], v[224:239]
    ds_read_b64_tr_b16 v[24:25], v6 offset:4096
    ds_read_b64_tr_b16 v[26:27], v6 offset:5120
    v_cvt_pk_bf16_f32 v242, v212, v213
    v_cvt_pk_bf16_f32 v243, v214, v215
    v_cvt_pk_bf16_f32 v244, v216, v217
    v_cvt_pk_bf16_f32 v245, v218, v219
    v_mfma_f32_32x32x16_bf16 v[224:239], v[36:39], v[196:199], v[224:239]
    ds_read_b64_tr_b16 v[28:29], v6 offset:6144
    ds_read_b64_tr_b16 v[30:31], v6 offset:7168
    ds_read_b32 v4, v102 offset:16
    v_cvt_pk_bf16_f32 v246, v220, v221
    v_cvt_pk_bf16_f32 v247, v222, v223
    s_waitcnt lgkmcnt(9)
    v_mfma_f32_32x32x16_bf16 v[224:239], v[40:43], v[200:203], v[224:239]
    s_barrier
    v_mfma_f32_32x32x16_bf16 v[224:239], v[44:47], v[204:207], v[224:239]
    ds_read_b64_tr_b16 v[32:33], v6 offset:8192
    ds_read_b64_tr_b16 v[34:35], v6 offset:9216
    ds_read_b64_tr_b16 v[36:37], v6 offset:10240
    ds_read_b64_tr_b16 v[38:39], v6 offset:11264
    s_waitcnt lgkmcnt(9)
    v_mfma_f32_32x32x16_bf16 v[208:223], v[16:19], v[112:115], 0
    ds_read_b64_tr_b16 v[40:41], v6 offset:12288
    ds_read_b64_tr_b16 v[42:43], v6 offset:13312
    v_mfma_f32_32x32x16_bf16 v[208:223], v[20:23], v[120:123], v[208:223]
    ds_read_b64_tr_b16 v[44:45], v6 offset:14336
    ds_read_b64_tr_b16 v[46:47], v6 offset:15360
    s_waitcnt lgkmcnt(8)
    v_cmp_eq_u32 vcc, 0, v4
    v_mfma_f32_32x32x16_bf16 v[208:223], v[24:27], v[128:131], v[208:223]
    s_cbranch_vccnz L_poll32
L_pollret32:
    v_add_u32 v7, v4, v100
    v_cvt_pk_bf16_f32 v248, v224, v225
    v_mfma_f32_32x32x16_bf16 v[208:223], v[28:31], v[136:139], v[208:223]
    ds_read_b64_tr_b16 v[16:17], v7 offset:0
    ds_read_b64_tr_b16 v[18:19], v7 offset:1024
    ds_read_b64_tr_b16 v[20:21], v7 offset:2048
    ds_read_b64_tr_b16 v[22:23], v7 offset:3072
    v_cvt_pk_bf16_f32 v249, v226, v227
    s_waitcnt lgkmcnt(8)
    v_mfma_f32_32x32x16_bf16 v[208:223], v[32:35], v[144:147], v[208:223]
    ds_read_b64_tr_b16 v[24:25], v7 offset:4096
    ds_read_b64_tr_b16 v[26:27], v7 offset:5120
    v_cvt_pk_bf16_f32 v250, v228, v229
    v_cvt_pk_bf16_f32 v251, v230, v231
    v_cvt_pk_bf16_f32 v252, v232, v233
    v_cvt_pk_bf16_f32 v253, v234, v235
    v_mfma_f32_32x32x16_bf16 v[208:223], v[36:39], v[152:155], v[208:223]
    ds_read_b64_tr_b16 v[28:29], v7 offset:6144
    ds_read_b64_tr_b16 v[30:31], v7 offset:7168
    ds_read_b32 v84, v101 offset:24
    v_cvt_pk_bf16_f32 v254, v236, v237
    v_cvt_pk_bf16_f32 v255, v238, v239
    s_waitcnt lgkmcnt(9)
    v_mfma_f32_32x32x16_bf16 v[208:223], v[40:43], v[160:163], v[208:223]
    ds_read_b64_tr_b16 v[32:33], v7 offset:8192
    ds_read_b64_tr_b16 v[34:35], v7 offset:9216
    v_mfma_f32_32x32x16_bf16 v[208:223], v[44:47], v[168:171], v[208:223]
    ds_read_b64_tr_b16 v[36:37], v7 offset:10240
    ds_read_b64_tr_b16 v[38:39], v7 offset:11264
    s_waitcnt lgkmcnt(9)
    v_mfma_f32_32x32x16_bf16 v[208:223], v[16:19], v[176:179], v[208:223]
    ds_read_b64_tr_b16 v[40:41], v7 offset:12288
    ds_read_b64_tr_b16 v[42:43], v7 offset:13312
    v_mfma_f32_32x32x16_bf16 v[208:223], v[20:23], v[180:183], v[208:223]
    ds_read_b64_tr_b16 v[44:45], v7 offset:14336
    ds_read_b64_tr_b16 v[46:47], v7 offset:15360
    s_waitcnt lgkmcnt(8)
    v_cmp_eq_u32 vcc, 0, v84
    v_mfma_f32_32x32x16_bf16 v[208:223], v[24:27], v[184:187], v[208:223]
    s_cbranch_vccnz L_poll33
L_pollret33:
    v_add_u32 v6, v84, v100
    v_mfma_f32_32x32x16_bf16 v[208:223], v[28:31], v[188:191], v[208:223]
    ds_read_b64_tr_b16 v[16:17], v6 offset:0
    ds_read_b64_tr_b16 v[18:19], v6 offset:1024
    ds_read_b64_tr_b16 v[20:21], v6 offset:2048
    ds_read_b64_tr_b16 v[22:23], v6 offset:3072
    s_waitcnt lgkmcnt(8)
    v_mfma_f32_32x32x16_bf16 v[208:223], v[32:35], v[192:195], v[208:223]
    ds_read_b64_tr_b16 v[24:25], v6 offset:4096
    ds_read_b64_tr_b16 v[26:27], v6 offset:5120
    v_mfma_f32_32x32x16_bf16 v[208:223], v[36:39], v[196:199], v[208:223]
    ds_read_b64_tr_b16 v[28:29], v6 offset:6144
    ds_read_b64_tr_b16 v[30:31], v6 offset:7168
    ds_read_b32 v4, v102 offset:24
    s_waitcnt lgkmcnt(9)
    v_mfma_f32_32x32x16_bf16 v[208:223], v[40:43], v[200:203], v[208:223]
    s_barrier
    v_mfma_f32_32x32x16_bf16 v[208:223], v[44:47], v[204:207], v[208:223]
    ds_read_b64_tr_b16 v[32:33], v6 offset:8192
    ds_read_b64_tr_b16 v[34:35], v6 offset:9216
    ds_read_b64_tr_b16 v[36:37], v6 offset:10240
    ds_read_b64_tr_b16 v[38:39], v6 offset:11264
    s_waitcnt lgkmcnt(9)
    v_mfma_f32_32x32x16_bf16 v[224:239], v[16:19], v[112:115], 0
    ds_read_b64_tr_b16 v[40:41], v6 offset:12288
    ds_read_b64_tr_b16 v[42:43], v6 offset:13312
    v_mfma_f32_32x32x16_bf16 v[224:239], v[20:23], v[120:123], v[224:239]
    ds_read_b64_tr_b16 v[44:45], v6 offset:14336
    ds_read_b64_tr_b16 v[46:47], v6 offset:15360
    s_waitcnt lgkmcnt(8)
    v_cmp_eq_u32 vcc, 0, v4
    v_mfma_f32_32x32x16_bf16 v[224:239], v[24:27], v[128:131], v[224:239]
    s_cbranch_vccnz L_poll34
L_pollret34:
    v_add_u32 v7, v4, v100
    v_cvt_pk_bf16_f32 v116, v208, v209
    v_mfma_f32_32x32x16_bf16 v[224:239], v[28:31], v[136:139], v[224:239]
    ds_read_b64_tr_b16 v[16:17], v7 offset:0
    ds_read_b64_tr_b16 v[18:19], v7 offset:1024
    ds_read_b64_tr_b16 v[20:21], v7 offset:2048
    ds_read_b64_tr_b16 v[22:23], v7 offset:3072
    v_cvt_pk_bf16_f32 v117, v210, v211
    s_waitcnt lgkmcnt(8)
    v_mfma_f32_32x32x16_bf16 v[224:239], v[32:35], v[144:147], v[224:239]
    ds_read_b64_tr_b16 v[24:25], v7 offset:4096
    ds_read_b64_tr_b16 v[26:27], v7 offset:5120
    v_cvt_pk_bf16_f32 v118, v212, v213
    v_cvt_pk_bf16_f32 v119, v214, v215
    v_cvt_pk_bf16_f32 v124, v216, v217
    v_cvt_pk_bf16_f32 v125, v218, v219
    v_mfma_f32_32x32x16_bf16 v[224:239], v[36:39], v[152:155], v[224:239]
    ds_read_b64_tr_b16 v[28:29], v7 offset:6144
    ds_read_b64_tr_b16 v[30:31], v7 offset:7168
    ds_read_b32 v84, v101 offset:32
    v_cvt_pk_bf16_f32 v126, v220, v221
    v_cvt_pk_bf16_f32 v127, v222, v223
    s_waitcnt lgkmcnt(9)
    v_mfma_f32_32x32x16_bf16 v[224:239], v[40:43], v[160:163], v[224:239]
    ds_read_b64_tr_b16 v[32:33], v7 offset:8192
    ds_read_b64_tr_b16 v[34:35], v7 offset:9216
    v_mfma_f32_32x32x16_bf16 v[224:239], v[44:47], v[168:171], v[224:239]
    ds_read_b64_tr_b16 v[36:37], v7 offset:10240
    ds_read_b64_tr_b16 v[38:39], v7 offset:11264
    s_waitcnt lgkmcnt(9)
    v_mfma_f32_32x32x16_bf16 v[224:239], v[16:19], v[176:179], v[224:239]
    ds_read_b64_tr_b16 v[40:41], v7 offset:12288
    ds_read_b64_tr_b16 v[42:43], v7 offset:13312
    v_mfma_f32_32x32x16_bf16 v[224:239], v[20:23], v[180:183], v[224:239]
    ds_read_b64_tr_b16 v[44:45], v7 offset:14336
    ds_read_b64_tr_b16 v[46:47], v7 offset:15360
    s_waitcnt lgkmcnt(8)
    v_cmp_eq_u32 vcc, 0, v84
    v_mfma_f32_32x32x16_bf16 v[224:239], v[24:27], v[184:187], v[224:239]
    s_cbranch_vccnz L_poll35
L_pollret35:
    v_add_u32 v6, v84, v100
    v_mfma_f32_32x32x16_bf16 v[224:239], v[28:31], v[188:191], v[224:239]
    ds_read_b64_tr_b16 v[16:17], v6 offset:0
    ds_read_b64_tr_b16 v[18:19], v6 offset:1024
    ds_read_b64_tr_b16 v[20:21], v6 offset:2048
    ds_read_b64_tr_b16 v[22:23], v6 offset:3072
    s_waitcnt lgkmcnt(8)
    v_mfma_f32_32x32x16_bf16 v[224:239], v[32:35], v[192:195], v[224:239]
    ds_read_b64_tr_b16 v[24:25], v6 offset:4096
    ds_read_b64_tr_b16 v[26:27], v6 offset:5120
    v_mfma_f32_32x32x16_bf16 v[224:239], v[36:39], v[196:199], v[224:239]
    ds_read_b64_tr_b16 v[28:29], v6 offset:6144
    ds_read_b64_tr_b16 v[30:31], v6 offset:7168
    ds_read_b32 v4, v102 offset:32
    s_waitcnt lgkmcnt(9)
    v_mfma_f32_32x32x16_bf16 v[224:239], v[40:43], v[200:203], v[224:239]
    s_barrier
    v_mfma_f32_32x32x16_bf16 v[224:239], v[44:47], v[204:207], v[224:239]
    ds_read_b64_tr_b16 v[32:33], v6 offset:8192
    ds_read_b64_tr_b16 v[34:35], v6 offset:9216
    ds_read_b64_tr_b16 v[36:37], v6 offset:10240
    ds_read_b64_tr_b16 v[38:39], v6 offset:11264
    s_waitcnt lgkmcnt(9)
    v_mfma_f32_32x32x16_bf16 v[208:223], v[16:19], v[112:115], 0
    ds_read_b64_tr_b16 v[40:41], v6 offset:12288
    ds_read_b64_tr_b16 v[42:43], v6 offset:13312
    buffer_store_dwordx4 v[240:243], v79, s[28:31], s68 offen offset:0 sc0 sc1
    v_mfma_f32_32x32x16_bf16 v[208:223], v[20:23], v[120:123], v[208:223]
    ds_read_b64_tr_b16 v[44:45], v6 offset:14336
    ds_read_b64_tr_b16 v[46:47], v6 offset:15360
    s_waitcnt lgkmcnt(8)
    v_cmp_eq_u32 vcc, 0, v4
    v_mfma_f32_32x32x16_bf16 v[208:223], v[24:27], v[128:131], v[208:223]
    s_cbranch_vccnz L_poll36
L_pollret36:
    v_add_u32 v7, v4, v100
    v_cvt_pk_bf16_f32 v132, v224, v225
    v_mfma_f32_32x32x16_bf16 v[208:223], v[28:31], v[136:139], v[208:223]
    ds_read_b64_tr_b16 v[16:17], v7 offset:0
    ds_read_b64_tr_b16 v[18:19], v7 offset:1024
    ds_read_b64_tr_b16 v[20:21], v7 offset:2048
    ds_read_b64_tr_b16 v[22:23], v7 offset:3072
    v_cvt_pk_bf16_f32 v133, v226, v227
    s_waitcnt lgkmcnt(8)
    v_mfma_f32_32x32x16_bf16 v[208:223], v[32:35], v[144:147], v[208:223]
    ds_read_b64_tr_b16 v[24:25], v7 offset:4096
    ds_read_b64_tr_b16 v[26:27], v7 offset:5120
    v_cvt_pk_bf16_f32 v134, v228, v229
    v_cvt_pk_bf16_f32 v135, v230, v231
    v_cvt_pk_bf16_f32 v140, v232, v233
    v_cvt_pk_bf16_f32 v141, v234, v235
    v_mfma_f32_32x32x16_bf16 v[208:223], v[36:39], v[152:155], v[208:223]
    ds_read_b64_tr_b16 v[28:29], v7 offset:6144
    ds_read_b64_tr_b16 v[30:31], v7 offset:7168
    ds_read_b32 v84, v101 offset:40
    v_cvt_pk_bf16_f32 v142, v236, v237
    v_cvt_pk_bf16_f32 v143, v238, v239
    s_waitcnt lgkmcnt(9)
    v_mfma_f32_32x32x16_bf16 v[208:223], v[40:43], v[160:163], v[208:223]
    buffer_store_dwordx4 v[244:247], v79, s[28:31], s68 offen offset:1024 sc0 sc1
    s_add_u32 s68, s68, 8192
    ds_read_b64_tr_b16 v[32:33], v7 offset:8192
    ds_read_b64_tr_b16 v[34:35], v7 offset:9216
    v_mfma_f32_32x32x16_bf16 v[208:223], v[44:47], v[168:171], v[208:223]
    ds_read_b64_tr_b16 v[36:37], v7 offset:10240
    ds_read_b64_tr_b16 v[38:39], v7 offset:11264
    s_waitcnt lgkmcnt(9)
    v_mfma_f32_32x32x16_bf16 v[208:223], v[16:19], v[176:179], v[208:223]
    ds_read_b64_tr_b16 v[40:41], v7 offset:12288
    ds_read_b64_tr_b16 v[42:43], v7 offset:13312
    buffer_store_dwordx4 v[248:251], v79, s[28:31], s68 offen offset:0 sc0 sc1
    v_mfma_f32_32x32x16_bf16 v[208:223], v[20:23], v[180:183], v[208:223]
    ds_read_b64_tr_b16 v[44:45], v7 offset:14336
    ds_read_b64_tr_b16 v[46:47], v7 offset:15360
    s_waitcnt lgkmcnt(8)
    v_cmp_eq_u32 vcc, 0, v84
    v_mfma_f32_32x32x16_bf16 v[208:223], v[24:27], v[184:187], v[208:223]
    s_cbranch_vccnz L_poll37
L_pollret37:
    v_add_u32 v6, v84, v100
    v_mfma_f32_32x32x16_bf16 v[208:223], v[28:31], v[188:191], v[208:223]
    ds_read_b64_tr_b16 v[16:17], v6 offset:0
    ds_read_b64_tr_b16 v[18:19], v6 offset:1024
    ds_read_b64_tr_b16 v[20:21], v6 offset:2048
    ds_read_b64_tr_b16 v[22:23], v6 offset:3072
    s_waitcnt lgkmcnt(8)
    v_mfma_f32_32x32x16_bf16 v[208:223], v[32:35], v[192:195], v[208:223]
    ds_read_b64_tr_b16 v[24:25], v6 offset:4096
    ds_read_b64_tr_b16 v[26:27], v6 offset:5120
    buffer_store_dwordx4 v[252:255], v79, s[28:31], s68 offen offset:1024 sc0 sc1
    s_add_u32 s68, s68, 8192
    v_mfma_f32_32x32x16_bf16 v[208:223], v[36:39], v[196:199], v[208:223]
    ds_read_b64_tr_b16 v[28:29], v6 offset:6144
    ds_read_b64_tr_b16 v[30:31], v6 offset:7168
    ds_read_b32 v4, v102 offset:40
    s_waitcnt lgkmcnt(9)
    v_mfma_f32_32x32x16_bf16 v[208:223], v[40:43], v[200:203], v[208:223]
    s_barrier
    v_mfma_f32_32x32x16_bf16 v[208:223], v[44:47], v[204:207], v[208:223]
    ds_read_b64_tr_b16 v[32:33], v6 offset:8192
    ds_read_b64_tr_b16 v[34:35], v6 offset:9216
    ds_read_b64_tr_b16 v[36:37], v6 offset:10240
    ds_read_b64_tr_b16 v[38:39], v6 offset:11264
    s_waitcnt lgkmcnt(9)
    v_mfma_f32_32x32x16_bf16 v[224:239], v[16:19], v[112:115], 0
    ds_read_b64_tr_b16 v[40:41], v6 offset:12288
    ds_read_b64_tr_b16 v[42:43], v6 offset:13312
    buffer_store_dwordx4 v[116:119], v79, s[28:31], s68 offen offset:0 sc0 sc1
    v_mfma_f32_32x32x16_bf16 v[224:239], v[20:23], v[120:123], v[224:239]
    ds_read_b64_tr_b16 v[44:45], v6 offset:14336
    ds_read_b64_tr_b16 v[46:47], v6 offset:15360
    s_waitcnt lgkmcnt(8)
    v_cmp_eq_u32 vcc, 0, v4
    v_mfma_f32_32x32x16_bf16 v[224:239], v[24:27], v[128:131], v[224:239]
    s_cbranch_vccnz L_poll38
L_pollret38:
    v_add_u32 v7, v4, v100
    v_cvt_pk_bf16_f32 v148, v208, v209
    v_mfma_f32_32x32x16_bf16 v[224:239], v[28:31], v[136:139], v[224:239]
    ds_read_b64_tr_b16 v[16:17], v7 offset:0
    ds_read_b64_tr_b16 v[18:19], v7 offset:1024
    ds_read_b64_tr_b16 v[20:21], v7 offset:2048
    ds_read_b64_tr_b16 v[22:23], v7 offset:3072
    v_cvt_pk_bf16_f32 v149, v210, v211
    s_waitcnt lgkmcnt(8)
    v_mfma_f32_32x32x16_bf16 v[224:239], v[32:35], v[144:147], v[224:239]
    ds_read_b64_tr_b16 v[24:25], v7 offset:4096
    ds_read_b64_tr_b16 v[26:27], v7 offset:5120
    v_cvt_pk_bf16_f32 v150, v212, v213
    v_cvt_pk_bf16_f32 v151, v214, v215
    v_cvt_pk_bf16_f32 v156, v216, v217
    v_cvt_pk_bf16_f32 v157, v218, v219
    v_mfma_f32_32x32x16_bf16 v[224:239], v[36:39], v[152:155], v[224:239]
    ds_read_b64_tr_b16 v[28:29], v7 offset:6144
    ds_read_b64_tr_b16 v[30:31], v7 offset:7168
    ds_read_b32 v84, v101 offset:48
    v_cvt_pk_bf16_f32 v158, v220, v221
    v_cvt_pk_bf16_f32 v159, v222, v223
    s_waitcnt lgkmcnt(9)
    v_mfma_f32_32x32x16_bf16 v[224:239], v[40:43], v[160:163], v[224:239]
    buffer_store_dwordx4 v[124:127], v79, s[28:31], s68 offen offset:1024 sc0 sc1
    s_add_u32 s68, s68, 8192
    ds_read_b64_tr_b16 v[32:33], v7 offset:8192
    ds_read_b64_tr_b16 v[34:35], v7 offset:9216
    v_mfma_f32_32x32x16_bf16 v[224:239], v[44:47], v[168:171], v[224:239]
    ds_read_b64_tr_b16 v[36:37], v7 offset:10240
    ds_read_b64_tr_b16 v[38:39], v7 offset:11264
    s_waitcnt lgkmcnt(9)
    v_mfma_f32_32x32x16_bf16 v[224:239], v[16:19], v[176:179], v[224:239]
    ds_read_b64_tr_b16 v[40:41], v7 offset:12288
    ds_read_b64_tr_b16 v[42:43], v7 offset:13312
    buffer_store_dwordx4 v[132:135], v79, s[28:31], s68 offen offset:0 sc0 sc1
    v_mfma_f32_32x32x16_bf16 v[224:239], v[20:23], v[180:183], v[224:239]
    ds_read_b64_tr_b16 v[44:45], v7 offset:14336
    ds_read_b64_tr_b16 v[46:47], v7 offset:15360
    s_waitcnt lgkmcnt(8)
    v_cmp_eq_u32 vcc, 0, v84
    v_mfma_f32_32x32x16_bf16 v[224:239], v[24:27], v[184:187], v[224:239]
    s_cbranch_vccnz L_poll39
L_pollret39:
    v_add_u32 v6, v84, v100
    v_mfma_f32_32x32x16_bf16 v[224:239], v[28:31], v[188:191], v[224:239]
    ds_read_b64_tr_b16 v[16:17], v6 offset:0
    ds_read_b64_tr_b16 v[18:19], v6 offset:1024
    ds_read_b64_tr_b16 v[20:21], v6 offset:2048
    ds_read_b64_tr_b16 v[22:23], v6 offset:3072
    s_waitcnt lgkmcnt(8)
    v_mfma_f32_32x32x16_bf16 v[224:239], v[32:35], v[192:195], v[224:239]
    ds_read_b64_tr_b16 v[24:25], v6 offset:4096
    ds_read_b64_tr_b16 v[26:27], v6 offset:5120
    buffer_store_dwordx4 v[140:143], v79, s[28:31], s68 offen offset:1024 sc0 sc1
    s_add_u32 s68, s68, 8192
    v_mfma_f32_32x32x16_bf16 v[224:239], v[36:39], v[196:199], v[224:239]
    ds_read_b64_tr_b16 v[28:29], v6 offset:6144
    ds_read_b64_tr_b16 v[30:31], v6 offset:7168
    ds_read_b32 v4, v102 offset:48
    s_waitcnt lgkmcnt(9)
    v_mfma_f32_32x32x16_bf16 v[224:239], v[40:43], v[200:203], v[224:239]
    ds_read_b64_tr_b16 v[32:33], v6 offset:8192
    ds_read_b64_tr_b16 v[34:35], v6 offset:9216
    v_mfma_f32_32x32x16_bf16 v[224:239], v[44:47], v[204:207], v[224:239]
    ds_read_b64_tr_b16 v[36:37], v6 offset:10240
    ds_read_b64_tr_b16 v[38:39], v6 offset:11264
    s_waitcnt lgkmcnt(9)
    v_mfma_f32_32x32x16_bf16 v[208:223], v[16:19], v[112:115], 0
    ds_read_b64_tr_b16 v[40:41], v6 offset:12288
    ds_read_b64_tr_b16 v[42:43], v6 offset:13312
    buffer_store_dwordx4 v[148:151], v79, s[28:31], s68 offen offset:0 sc0 sc1
    v_mfma_f32_32x32x16_bf16 v[208:223], v[20:23], v[120:123], v[208:223]
    ds_read_b64_tr_b16 v[44:45], v6 offset:14336
    ds_read_b64_tr_b16 v[46:47], v6 offset:15360
    s_waitcnt lgkmcnt(8)
    v_cmp_eq_u32 vcc, 0, v4
    v_mfma_f32_32x32x16_bf16 v[208:223], v[24:27], v[128:131], v[208:223]
    s_cbranch_vccnz L_poll40
L_pollret40:
    v_add_u32 v7, v4, v100
    v_cvt_pk_bf16_f32 v164, v224, v225
    v_mfma_f32_32x32x16_bf16 v[208:223], v[28:31], v[136:139], v[208:223]
    ds_read_b64_tr_b16 v[16:17], v7 offset:0
    ds_read_b64_tr_b16 v[18:19], v7 offset:1024
    ds_read_b64_tr_b16 v[20:21], v7 offset:2048
    ds_read_b64_tr_b16 v[22:23], v7 offset:3072
    v_cvt_pk_bf16_f32 v165, v226, v227
    s_waitcnt lgkmcnt(8)
    v_mfma_f32_32x32x16_bf16 v[208:223], v[32:35], v[144:147], v[208:223]
    ds_read_b64_tr_b16 v[24:25], v7 offset:4096
    ds_read_b64_tr_b16 v[26:27], v7 offset:5120
    v_cvt_pk_bf16_f32 v166, v228, v229
    v_cvt_pk_bf16_f32 v167, v230, v231
    v_cvt_pk_bf16_f32 v172, v232, v233
    v_cvt_pk_bf16_f32 v173, v234, v235
    v_mfma_f32_32x32x16_bf16 v[208:223], v[36:39], v[152:155], v[208:223]
    ds_read_b64_tr_b16 v[28:29], v7 offset:6144
    ds_read_b64_tr_b16 v[30:31], v7 offset:7168
    ds_read_b32 v84, v101 offset:56
    v_cvt_pk_bf16_f32 v174, v236, v237
    v_cvt_pk_bf16_f32 v175, v238, v239
    s_waitcnt lgkmcnt(9)
    v_mfma_f32_32x32x16_bf16 v[208:223], v[40:43], v[160:163], v[208:223]
    buffer_store_dwordx4 v[156:159], v79, s[28:31], s68 offen offset:1024 sc0 sc1
    s_add_u32 s68, s68, 8192
    ds_read_b64_tr_b16 v[32:33], v7 offset:8192
    ds_read_b64_tr_b16 v[34:35], v7 offset:9216
    v_mfma_f32_32x32x16_bf16 v[208:223], v[44:47], v[168:171], v[208:223]
    ds_read_b64_tr_b16 v[36:37], v7 offset:10240
    ds_read_b64_tr_b16 v[38:39], v7 offset:11264
    s_waitcnt lgkmcnt(9)
    v_mfma_f32_32x32x16_bf16 v[208:223], v[16:19], v[176:179], v[208:223]
    ds_read_b64_tr_b16 v[40:41], v7 offset:12288
    ds_read_b64_tr_b16 v[42:43], v7 offset:13312
    buffer_store_dwordx4 v[164:167], v79, s[28:31], s68 offen offset:0 sc0 sc1
    v_mfma_f32_32x32x16_bf16 v[208:223], v[20:23], v[180:183], v[208:223]
    ds_read_b64_tr_b16 v[44:45], v7 offset:14336
    ds_read_b64_tr_b16 v[46:47], v7 offset:15360
    s_waitcnt lgkmcnt(8)
    v_cmp_eq_u32 vcc, 0, v84
    v_mfma_f32_32x32x16_bf16 v[208:223], v[24:27], v[184:187], v[208:223]
    s_cbranch_vccnz L_poll41
L_pollret41:
    v_add_u32 v6, v84, v100
    v_mfma_f32_32x32x16_bf16 v[208:223], v[28:31], v[188:191], v[208:223]
    ds_read_b64_tr_b16 v[16:17], v6 offset:0
    ds_read_b64_tr_b16 v[18:19], v6 offset:1024
    ds_read_b64_tr_b16 v[20:21], v6 offset:2048
    ds_read_b64_tr_b16 v[22:23], v6 offset:3072
    s_waitcnt lgkmcnt(8)
    v_mfma_f32_32x32x16_bf16 v[208:223], v[32:35], v[192:195], v[208:223]
    ds_read_b64_tr_b16 v[24:25], v6 offset:4096
    ds_read_b64_tr_b16 v[26:27], v6 offset:5120
    buffer_store_dwordx4 v[172:175], v79, s[28:31], s68 offen offset:1024 sc0 sc1
    s_add_u32 s68, s68, 8192
    v_mfma_f32_32x32x16_bf16 v[208:223], v[36:39], v[196:199], v[208:223]
    ds_read_b64_tr_b16 v[28:29], v6 offset:6144
    ds_read_b64_tr_b16 v[30:31], v6 offset:7168
    ds_read_b32 v4, v102 offset:56
    s_waitcnt lgkmcnt(9)
    v_mfma_f32_32x32x16_bf16 v[208:223], v[40:43], v[200:203], v[208:223]
    ds_read_b64_tr_b16 v[32:33], v6 offset:8192
    ds_read_b64_tr_b16 v[34:35], v6 offset:9216
    v_mfma_f32_32x32x16_bf16 v[208:223], v[44:47], v[204:207], v[208:223]
    ds_read_b64_tr_b16 v[36:37], v6 offset:10240
    ds_read_b64_tr_b16 v[38:39], v6 offset:11264
    s_waitcnt lgkmcnt(9)
    v_mfma_f32_32x32x16_bf16 v[224:239], v[16:19], v[112:115], 0
    ds_read_b64_tr_b16 v[40:41], v6 offset:12288
    ds_read_b64_tr_b16 v[42:43], v6 offset:13312
    v_mfma_f32_32x32x16_bf16 v[224:239], v[20:23], v[120:123], v[224:239]
    ds_read_b64_tr_b16 v[44:45], v6 offset:14336
    ds_read_b64_tr_b16 v[46:47], v6 offset:15360
    s_waitcnt lgkmcnt(8)
    v_cmp_eq_u32 vcc, 0, v4
    v_mfma_f32_32x32x16_bf16 v[224:239], v[24:27], v[128:131], v[224:239]
    s_cbranch_vccnz L_poll42
L_pollret42:
    v_add_u32 v7, v4, v100
    v_cvt_pk_bf16_f32 v48, v208, v209
    v_mfma_f32_32x32x16_bf16 v[224:239], v[28:31], v[136:139], v[224:239]
    ds_read_b64_tr_b16 v[16:17], v7 offset:0
    ds_read_b64_tr_b16 v[18:19], v7 offset:1024
    ds_read_b64_tr_b16 v[20:21], v7 offset:2048
    ds_read_b64_tr_b16 v[22:23], v7 offset:3072
    v_cvt_pk_bf16_f32 v49, v210, v211
    s_waitcnt lgkmcnt(8)
    v_mfma_f32_32x32x16_bf16 v[224:239], v[32:35], v[144:147], v[224:239]
    ds_read_b64_tr_b16 v[24:25], v7 offset:4096
    ds_read_b64_tr_b16 v[26:27], v7 offset:5120
    v_cvt_pk_bf16_f32 v50, v212, v213
    v_cvt_pk_bf16_f32 v51, v214, v215
    v_cvt_pk_bf16_f32 v56, v216, v217
    v_cvt_pk_bf16_f32 v57, v218, v219
    v_mfma_f32_32x32x16_bf16 v[224:239], v[36:39], v[152:155], v[224:239]
    ds_read_b64_tr_b16 v[28:29], v7 offset:6144
    ds_read_b64_tr_b16 v[30:31], v7 offset:7168
    ds_read_b32 v84, v101 offset:64
    v_cvt_pk_bf16_f32 v58, v220, v221
    v_cvt_pk_bf16_f32 v59, v222, v223
    s_waitcnt lgkmcnt(9)
    v_mfma_f32_32x32x16_bf16 v[224:239], v[40:43], v[160:163], v[224:239]
    ds_read_b64_tr_b16 v[32:33], v7 offset:8192
    ds_read_b64_tr_b16 v[34:35], v7 offset:9216
    v_mfma_f32_32x32x16_bf16 v[224:239], v[44:47], v[168:171], v[224:239]
    ds_read_b64_tr_b16 v[36:37], v7 offset:10240
    ds_read_b64_tr_b16 v[38:39], v7 offset:11264
    buffer_store_dwordx4 v[48:51], v79, s[28:31], s68 offen offset:0 sc0 sc1
    s_waitcnt lgkmcnt(9)
    v_mfma_f32_32x32x16_bf16 v[224:239], v[16:19], v[176:179], v[224:239]
    buffer_store_dwordx4 v[56:59], v79, s[28:31], s68 offen offset:1024 sc0 sc1
    s_add_u32 s68, s68, 8192
    ds_read_b64_tr_b16 v[40:41], v7 offset:12288
    ds_read_b64_tr_b16 v[42:43], v7 offset:13312
    v_mfma_f32_32x32x16_bf16 v[224:239], v[20:23], v[180:183], v[224:239]
    ds_read_b64_tr_b16 v[44:45], v7 offset:14336
    ds_read_b64_tr_b16 v[46:47], v7 offset:15360
    s_waitcnt lgkmcnt(8)
    v_cmp_eq_u32 vcc, 0, v84
    v_mfma_f32_32x32x16_bf16 v[224:239], v[24:27], v[184:187], v[224:239]
    v_lshlrev_b32 v87, 7, v1
    s_mov_b64 exec, 3
    s_waitcnt vmcnt(6)
    buffer_store_dword v5, v87, s[28:31], s98 offen offset:256 sc0 sc1
    s_mov_b64 exec, -1
    v_mfma_f32_32x32x16_bf16 v[224:239], v[28:31], v[188:191], v[224:239]
    s_cbranch_vccnz L_poll43
L_pollret43:
    v_add_u32 v6, v84, v100
    s_waitcnt lgkmcnt(4)
    v_mfma_f32_32x32x16_bf16 v[224:239], v[32:35], v[192:195], v[224:239]
    ds_read_b64_tr_b16 v[16:17], v6 offset:0
    ds_read_b64_tr_b16 v[18:19], v6 offset:1024
    ds_read_b64_tr_b16 v[20:21], v6 offset:2048
    ds_read_b64_tr_b16 v[22:23], v6 offset:3072
    ds_read_b64_tr_b16 v[24:25], v6 offset:4096
    ds_read_b64_tr_b16 v[26:27], v6 offset:5120
    v_mfma_f32_32x32x16_bf16 v[224:239], v[36:39], v[196:199], v[224:239]
    ds_read_b64_tr_b16 v[28:29], v6 offset:6144
    ds_read_b64_tr_b16 v[30:31], v6 offset:7168
    ds_read_b32 v4, v102 offset:64
    s_waitcnt lgkmcnt(9)
    v_mfma_f32_32x32x16_bf16 v[224:239], v[40:43], v[200:203], v[224:239]
    ds_read_b64_tr_b16 v[32:33], v6 offset:8192
    ds_read_b64_tr_b16 v[34:35], v6 offset:9216
    v_mfma_f32_32x32x16_bf16 v[224:239], v[44:47], v[204:207], v[224:239]
    ds_read_b64_tr_b16 v[36:37], v6 offset:10240
    ds_read_b64_tr_b16 v[38:39], v6 offset:11264
    s_waitcnt lgkmcnt(9)
    v_mfma_f32_32x32x16_bf16 v[208:223], v[16:19], v[112:115], 0
    ds_read_b64_tr_b16 v[40:41], v6 offset:12288
    ds_read_b64_tr_b16 v[42:43], v6 offset:13312
    v_mfma_f32_32x32x16_bf16 v[208:223], v[20:23], v[120:123], v[208:223]
    ds_read_b64_tr_b16 v[44:45], v6 offset:14336
    ds_read_b64_tr_b16 v[46:47], v6 offset:15360
    s_waitcnt lgkmcnt(8)
    v_cmp_eq_u32 vcc, 0, v4
    v_mfma_f32_32x32x16_bf16 v[208:223], v[24:27], v[128:131], v[208:223]
    s_cbranch_vccnz L_poll44
L_pollret44:
    v_add_u32 v7, v4, v100
    v_cvt_pk_bf16_f32 v64, v224, v225
    v_mfma_f32_32x32x16_bf16 v[208:223], v[28:31], v[136:139], v[208:223]
    ds_read_b64_tr_b16 v[16:17], v7 offset:0
    ds_read_b64_tr_b16 v[18:19], v7 offset:1024
    ds_read_b64_tr_b16 v[20:21], v7 offset:2048
    ds_read_b64_tr_b16 v[22:23], v7 offset:3072
    v_cvt_pk_bf16_f32 v65, v226, v227
    s_waitcnt lgkmcnt(8)
    v_mfma_f32_32x32x16_bf16 v[208:223], v[32:35], v[144:147], v[208:223]
    ds_read_b64_tr_b16 v[24:25], v7 offset:4096
    ds_read_b64_tr_b16 v[26:27], v7 offset:5120
    v_cvt_pk_bf16_f32 v66, v228, v229
    v_cvt_pk_bf16_f32 v67, v230, v231
    v_cvt_pk_bf16_f32 v72, v232, v233
    v_cvt_pk_bf16_f32 v73, v234, v235
    v_mfma_f32_32x32x16_bf16 v[208:223], v[36:39], v[152:155], v[208:223]
    ds_read_b64_tr_b16 v[28:29], v7 offset:6144
    ds_read_b64_tr_b16 v[30:31], v7 offset:7168
    v_cvt_pk_bf16_f32 v74, v236, v237
    v_cvt_pk_bf16_f32 v75, v238, v239
    s_waitcnt lgkmcnt(8)
    v_mfma_f32_32x32x16_bf16 v[208:223], v[40:43], v[160:163], v[208:223]
    ds_read_b64_tr_b16 v[32:33], v7 offset:8192
    ds_read_b64_tr_b16 v[34:35], v7 offset:9216
    v_mfma_f32_32x32x16_bf16 v[208:223], v[44:47], v[168:171], v[208:223]
    ds_read_b64_tr_b16 v[36:37], v7 offset:10240
    ds_read_b64_tr_b16 v[38:39], v7 offset:11264
    buffer_store_dwordx4 v[64:67], v79, s[28:31], s68 offen offset:0 sc0 sc1
    s_waitcnt lgkmcnt(8)
    v_mfma_f32_32x32x16_bf16 v[208:223], v[16:19], v[176:179], v[208:223]
    buffer_store_dwordx4 v[72:75], v79, s[28:31], s68 offen offset:1024 sc0 sc1
    s_add_u32 s68, s68, 8192
    ds_read_b64_tr_b16 v[40:41], v7 offset:12288
    ds_read_b64_tr_b16 v[42:43], v7 offset:13312
    v_mfma_f32_32x32x16_bf16 v[208:223], v[20:23], v[180:183], v[208:223]
    ds_read_b64_tr_b16 v[44:45], v7 offset:14336
    ds_read_b64_tr_b16 v[46:47], v7 offset:15360
    s_waitcnt lgkmcnt(8)
    v_mfma_f32_32x32x16_bf16 v[208:223], v[24:27], v[184:187], v[208:223]
    v_mfma_f32_32x32x16_bf16 v[208:223], v[28:31], v[188:191], v[208:223]
    s_waitcnt lgkmcnt(4)
    v_mfma_f32_32x32x16_bf16 v[208:223], v[32:35], v[192:195], v[208:223]
    v_mfma_f32_32x32x16_bf16 v[208:223], v[36:39], v[196:199], v[208:223]
    s_waitcnt lgkmcnt(0)
    v_mfma_f32_32x32x16_bf16 v[208:223], v[40:43], v[200:203], v[208:223]
    v_mfma_f32_32x32x16_bf16 v[208:223], v[44:47], v[204:207], v[208:223]
    s_nop 11
    v_cvt_pk_bf16_f32 v88, v208, v209
    v_cvt_pk_bf16_f32 v89, v210, v211
    v_cvt_pk_bf16_f32 v90, v212, v213
    v_cvt_pk_bf16_f32 v91, v214, v215
    v_cvt_pk_bf16_f32 v96, v216, v217
    v_cvt_pk_bf16_f32 v97, v218, v219
    v_cvt_pk_bf16_f32 v98, v220, v221
    v_cvt_pk_bf16_f32 v99, v222, v223
    buffer_store_dwordx4 v[88:91], v79, s[28:31], s68 offen offset:0 sc0 sc1
    buffer_store_dwordx4 v[96:99], v79, s[28:31], s68 offen offset:1024 sc0 sc1
    s_add_u32 s68, s68, 8192
    v_lshlrev_b32 v87, 7, v1
    s_mov_b64 exec, 28
    s_waitcnt vmcnt(0)
    buffer_store_dword v5, v87, s[28:31], s98 offen offset:256 sc0 sc1
    s_mov_b64 exec, -1
    s_setprio 0
    s_cmp_lt_u32 s3, 2
    s_cbranch_scc1 L_red
L_end:
    s_endpgm
L_poll1:
    ds_read_b32 v4, v3 offset:16
    s_add_u32 s100, s100, 1
    s_cmp_gt_u32 s100, 0x100000
    s_cbranch_scc1 L_end
    s_waitcnt lgkmcnt(0)
    v_cmp_eq_u32 vcc, 0, v4
    s_cbranch_vccnz L_poll1
    s_branch L_pollret1
L_poll2:
    ds_read_b32 v4, v3 offset:20
    s_add_u32 s100, s100, 1
    s_cmp_gt_u32 s100, 0x100000
    s_cbranch_scc1 L_end
    s_waitcnt lgkmcnt(0)
    v_cmp_eq_u32 vcc, 0, v4
    s_cbranch_vccnz L_poll2
    s_branch L_pollret2
L_poll3:
    ds_read_b32 v4, v3 offset:24
    s_add_u32 s100, s100, 1
    s_cmp_gt_u32 s100, 0x100000
    s_cbranch_scc1 L_end
    s_waitcnt lgkmcnt(0)
    v_cmp_eq_u32 vcc, 0, v4
    s_cbranch_vccnz L_poll3
    s_branch L_pollret3
L_poll4:
    ds_read_b32 v4, v3 offset:28
    s_add_u32 s100, s100, 1
    s_cmp_gt_u32 s100, 0x100000
    s_cbranch_scc1 L_end
    s_waitcnt lgkmcnt(0)
    v_cmp_eq_u32 vcc, 0, v4
    s_cbranch_vccnz L_poll4
    s_branch L_pollret4
L_poll5:
    ds_read_b32 v4, v3 offset:32
    s_add_u32 s100, s100, 1
    s_cmp_gt_u32 s100, 0x100000
    s_cbranch_scc1 L_end
    s_waitcnt lgkmcnt(0)
    v_cmp_eq_u32 vcc, 0, v4
    s_cbranch_vccnz L_poll5
    s_branch L_pollret5
L_poll6:
    ds_read_b32 v4, v3 offset:36
    s_add_u32 s100, s100, 1
    s_cmp_gt_u32 s100, 0x100000
    s_cbranch_scc1 L_end
    s_waitcnt lgkmcnt(0)
    v_cmp_eq_u32 vcc, 0, v4
    s_cbranch_vccnz L_poll6
    s_branch L_pollret6
L_poll7:
    ds_read_b32 v4, v3 offset:40
    s_add_u32 s100, s100, 1
    s_cmp_gt_u32 s100, 0x100000
    s_cbranch_scc1 L_end
    s_waitcnt lgkmcnt(0)
    v_cmp_eq_u32 vcc, 0, v4
    s_cbranch_vccnz L_poll7
    s_branch L_pollret7
L_poll8:
    ds_read_b32 v4, v3 offset:44
    s_add_u32 s100, s100, 1
    s_cmp_gt_u32 s100, 0x100000
    s_cbranch_scc1 L_end
    s_waitcnt lgkmcnt(0)
    v_cmp_eq_u32 vcc, 0, v4
    s_cbranch_vccnz L_poll8
    s_branch L_pollret8
L_poll9:
    ds_read_b32 v4, v3 offset:48
    s_add_u32 s100, s100, 1
    s_cmp_gt_u32 s100, 0x100000
    s_cbranch_scc1 L_end
    s_waitcnt lgkmcnt(0)
    v_cmp_eq_u32 vcc, 0, v4
    s_cbranch_vccnz L_poll9
    s_branch L_pollret9
L_poll10:
    ds_read_b32 v4, v3 offset:52
    s_add_u32 s100, s100, 1
    s_cmp_gt_u32 s100, 0x100000
    s_cbranch_scc1 L_end
    s_waitcnt lgkmcnt(0)
    v_cmp_eq_u32 vcc, 0, v4
    s_cbranch_vccnz L_poll10
    s_branch L_pollret10
L_poll11:
    ds_read_b32 v4, v3 offset:56
    s_add_u32 s100, s100, 1
    s_cmp_gt_u32 s100, 0x100000
    s_cbranch_scc1 L_end
    s_waitcnt lgkmcnt(0)
    v_cmp_eq_u32 vcc, 0, v4
    s_cbranch_vccnz L_poll11
    s_branch L_pollret11
L_poll12:
    ds_read_b32 v4, v3 offset:60
    s_add_u32 s100, s100, 1
    s_cmp_gt_u32 s100, 0x100000
    s_cbranch_scc1 L_end
    s_waitcnt lgkmcnt(0)
    v_cmp_eq_u32 vcc, 0, v4
    s_cbranch_vccnz L_poll12
    s_branch L_pollret12
L_poll13:
    ds_read_b32 v4, v3 offset:64
    s_add_u32 s100, s100, 1
    s_cmp_gt_u32 s100, 0x100000
    s_cbranch_scc1 L_end
    s_waitcnt lgkmcnt(0)
    v_cmp_eq_u32 vcc, 0, v4
    s_cbranch_vccnz L_poll13
    s_branch L_pollret13
L_poll14:
    ds_read_b32 v4, v3 offset:68
    s_add_u32 s100, s100, 1
    s_cmp_gt_u32 s100, 0x100000
    s_cbranch_scc1 L_end
    s_waitcnt lgkmcnt(0)
    v_cmp_eq_u32 vcc, 0, v4
    s_cbranch_vccnz L_poll14
    s_branch L_pollret14
L_poll15:
    ds_read_b32 v4, v3 offset:72
    s_add_u32 s100, s100, 1
    s_cmp_gt_u32 s100, 0x100000
    s_cbranch_scc1 L_end
    s_waitcnt lgkmcnt(0)
    v_cmp_eq_u32 vcc, 0, v4
    s_cbranch_vccnz L_poll15
    s_branch L_pollret15
L_poll16:
    ds_read_b32 v4, v3 offset:76
    s_add_u32 s100, s100, 1
    s_cmp_gt_u32 s100, 0x100000
    s_cbranch_scc1 L_end
    s_waitcnt lgkmcnt(0)
    v_cmp_eq_u32 vcc, 0, v4
    s_cbranch_vccnz L_poll16
    s_branch L_pollret16
L_poll17:
    ds_read_b32 v4, v3 offset:80
    s_add_u32 s100, s100, 1
    s_cmp_gt_u32 s100, 0x100000
    s_cbranch_scc1 L_end
    s_waitcnt lgkmcnt(0)
    v_cmp_eq_u32 vcc, 0, v4
    s_cbranch_vccnz L_poll17
    s_branch L_pollret17
L_poll18:
    ds_read_b32 v4, v3 offset:84
    s_add_u32 s100, s100, 1
    s_cmp_gt_u32 s100, 0x100000
    s_cbranch_scc1 L_end
    s_waitcnt lgkmcnt(0)
    v_cmp_eq_u32 vcc, 0, v4
    s_cbranch_vccnz L_poll18
    s_branch L_pollret18
L_x2p:
    ds_read_b32 v2, v9 offset:8
    s_add_u32 s100, s100, 1
    s_cmp_gt_u32 s100, 0x100000
    s_cbranch_scc1 L_end
    s_waitcnt lgkmcnt(0)
    v_cmp_eq_u32 s[62:63], 0, v2
    s_nop 0
    s_cmp_lg_u64 s[62:63], 0
    s_cbranch_scc1 L_x2p
    s_branch L_x2r
L_poll19:
    ds_read_b32 v4, v3 offset:88
    s_add_u32 s100, s100, 1
    s_cmp_gt_u32 s100, 0x100000
    s_cbranch_scc1 L_end
    s_waitcnt lgkmcnt(0)
    v_cmp_eq_u32 vcc, 0, v4
    s_cbranch_vccnz L_poll19
    s_branch L_pollret19
L_poll20:
    ds_read_b32 v4, v3 offset:0
    s_add_u32 s100, s100, 1
    s_cmp_gt_u32 s100, 0x100000
    s_cbranch_scc1 L_end
    s_waitcnt lgkmcnt(0)
    v_cmp_eq_u32 vcc, 0, v4
    s_cbranch_vccnz L_poll20
    s_branch L_pollret20
L_poll21:
    ds_read_b32 v4, v3 offset:4
    s_add_u32 s100, s100, 1
    s_cmp_gt_u32 s100, 0x100000
    s_cbranch_scc1 L_end
    s_waitcnt lgkmcnt(0)
    v_cmp_eq_u32 vcc, 0, v4
    s_cbranch_vccnz L_poll21
    s_branch L_pollret21
L_poll22:
    ds_read_b32 v4, v3 offset:8
    s_add_u32 s100, s100, 1
    s_cmp_gt_u32 s100, 0x100000
    s_cbranch_scc1 L_end
    s_waitcnt lgkmcnt(0)
    v_cmp_eq_u32 vcc, 0, v4
    s_cbranch_vccnz L_poll22
    s_branch L_pollret22
L_rarei:
    v_mov_b32 v78, v54
    s_nop 1
    v_permlane32_swap_b32 v78, v54
    v_max3_f32 v54, v54, v78, 0
    v_exp_f32 v76, -v54
    v_sub_f32 v208, v208, v54
    v_sub_f32 v209, v209, v54
    v_sub_f32 v210, v210, v54
    v_sub_f32 v211, v211, v54
    v_sub_f32 v212, v212, v54
    v_sub_f32 v213, v213, v54
    v_sub_f32 v214, v214, v54
    v_sub_f32 v215, v215, v54
    v_sub_f32 v216, v216, v54
    v_sub_f32 v217, v217, v54
    v_sub_f32 v218, v218, v54
    v_sub_f32 v219, v219, v54
    v_sub_f32 v220, v220, v54
    v_sub_f32 v221, v221, v54
    v_sub_f32 v222, v222, v54
    v_sub_f32 v223, v223, v54
    v_sub_f32 v224, v224, v54
    v_sub_f32 v225, v225, v54
    v_sub_f32 v226, v226, v54
    v_sub_f32 v227, v227, v54
    v_sub_f32 v228, v228, v54
    v_sub_f32 v229, v229, v54
    v_sub_f32 v230, v230, v54
    v_sub_f32 v231, v231, v54
    v_sub_f32 v232, v232, v54
    v_sub_f32 v233, v233, v54
    v_sub_f32 v234, v234, v54
    v_sub_f32 v235, v235, v54
    v_sub_f32 v236, v236, v54
    v_sub_f32 v237, v237, v54
    v_sub_f32 v238, v238, v54
    v_sub_f32 v239, v239, v54
    v_sub_f32 v240, v240, v54
    v_sub_f32 v241, v241, v54
    v_sub_f32 v242, v242, v54
    v_sub_f32 v243, v243, v54
    v_sub_f32 v244, v244, v54
    v_sub_f32 v245, v245, v54
    v_sub_f32 v246, v246, v54
    v_sub_f32 v247, v247, v54
    v_sub_f32 v248, v248, v54
    v_sub_f32 v249, v249, v54
    v_sub_f32 v250, v250, v54
    v_sub_f32 v251, v251, v54
    v_sub_f32 v252, v252, v54
    v_sub_f32 v253, v253, v54
    v_sub_f32 v254, v254, v54
    v_sub_f32 v255, v255, v54
    s_mov_b32 s64, 1
    s_nop 1
    s_branch L_rarereti
L_poll23:
    ds_read_b32 v4, v3 offset:12
    s_add_u32 s100, s100, 1
    s_cmp_gt_u32 s100, 0x100000
    s_cbranch_scc1 L_end
    s_waitcnt lgkmcnt(0)
    v_cmp_eq_u32 vcc, 0, v4
    s_cbranch_vccnz L_poll23
    s_branch L_pollret23
L_poll24:
    ds_read_b32 v4, v3 offset:16
    s_add_u32 s100, s100, 1
    s_cmp_gt_u32 s100, 0x100000
    s_cbranch_scc1 L_end
    s_waitcnt lgkmcnt(0)
    v_cmp_eq_u32 vcc, 0, v4
    s_cbranch_vccnz L_poll24
    s_branch L_pollret24
L_rareo:
    v_mov_b32 v78, v54
    s_nop 1
    v_permlane32_swap_b32 v78, v54
    v_max3_f32 v54, v54, v78, 0
    v_exp_f32 v76, -v54
    v_sub_f32 v176, v176, v54
    v_sub_f32 v177, v177, v54
    v_sub_f32 v178, v178, v54
    v_sub_f32 v179, v179, v54
    v_sub_f32 v180, v180, v54
    v_sub_f32 v181, v181, v54
    v_sub_f32 v182, v182, v54
    v_sub_f32 v183, v183, v54
    v_sub_f32 v184, v184, v54
    v_sub_f32 v185, v185, v54
    v_sub_f32 v186, v186, v54
    v_sub_f32 v187, v187, v54
    v_sub_f32 v188, v188, v54
    v_sub_f32 v189, v189, v54
    v_sub_f32 v190, v190, v54
    v_sub_f32 v191, v191, v54
    v_sub_f32 v192, v192, v54
    v_sub_f32 v193, v193, v54
    v_sub_f32 v194, v194, v54
    v_sub_f32 v195, v195, v54
    v_sub_f32 v196, v196, v54
    v_sub_f32 v197, v197, v54
    v_sub_f32 v198, v198, v54
    v_sub_f32 v199, v199, v54
    v_sub_f32 v200, v200, v54
    v_sub_f32 v201, v201, v54
    v_sub_f32 v202, v202, v54
    v_sub_f32 v203, v203, v54
    v_sub_f32 v204, v204, v54
    v_sub_f32 v205, v205, v54
    v_sub_f32 v206, v206, v54
    v_sub_f32 v207, v207, v54
    v_sub_f32 v240, v240, v54
    v_sub_f32 v241, v241, v54
    v_sub_f32 v242, v242, v54
    v_sub_f32 v243, v243, v54
    v_sub_f32 v244, v244, v54
    v_sub_f32 v245, v245, v54
    v_sub_f32 v246, v246, v54
    v_sub_f32 v247, v247, v54
    v_sub_f32 v248, v248, v54
    v_sub_f32 v249, v249, v54
    v_sub_f32 v250, v250, v54
    v_sub_f32 v251, v251, v54
    v_sub_f32 v252, v252, v54
    v_sub_f32 v253, v253, v54
    v_sub_f32 v254, v254, v54
    v_sub_f32 v255, v255, v54
    s_mov_b32 s64, 1
    s_nop 1
    s_branch L_rarereto
L_resco:
    s_nop 15
    v_mul_f32 v112, v112, v76
    v_mul_f32 v113, v113, v76
    v_mul_f32 v114, v114, v76
    v_mul_f32 v115, v115, v76
    v_mul_f32 v116, v116, v76
    v_mul_f32 v117, v117, v76
    v_mul_f32 v118, v118, v76
    v_mul_f32 v119, v119, v76
    v_mul_f32 v120, v120, v76
    v_mul_f32 v121, v121, v76
    v_mul_f32 v122, v122, v76
    v_mul_f32 v123, v123, v76
    v_mul_f32 v124, v124, v76
    v_mul_f32 v125, v125, v76
    v_mul_f32 v126, v126, v76
    v_mul_f32 v127, v127, v76
    v_mul_f32 v128, v128, v76
    v_mul_f32 v129, v129, v76
    v_mul_f32 v130, v130, v76
    v_mul_f32 v131, v131, v76
    v_mul_f32 v132, v132, v76
    v_mul_f32 v133, v133, v76
    v_mul_f32 v134, v134, v76
    v_mul_f32 v135, v135, v76
    v_mul_f32 v136, v136, v76
    v_mul_f32 v137, v137, v76
    v_mul_f32 v138, v138, v76
    v_mul_f32 v139, v139, v76
    v_mul_f32 v140, v140, v76
    v_mul_f32 v141, v141, v76
    v_mul_f32 v142, v142, v76
    v_mul_f32 v143, v143, v76
    v_mul_f32 v144, v144, v76
    v_mul_f32 v145, v145, v76
    v_mul_f32 v146, v146, v76
    v_mul_f32 v147, v147, v76
    v_mul_f32 v148, v148, v76
    v_mul_f32 v149, v149, v76
    v_mul_f32 v150, v150, v76
    v_mul_f32 v151, v151, v76
    v_mul_f32 v152, v152, v76
    v_mul_f32 v153, v153, v76
    v_mul_f32 v154, v154, v76
    v_mul_f32 v155, v155, v76
    v_mul_f32 v156, v156, v76
    v_mul_f32 v157, v157, v76
    v_mul_f32 v158, v158, v76
    v_mul_f32 v159, v159, v76
    v_mul_f32 v160, v160, v76
    v_mul_f32 v161, v161, v76
    v_mul_f32 v162, v162, v76
    v_mul_f32 v163, v163, v76
    v_mul_f32 v164, v164, v76
    v_mul_f32 v165, v165, v76
    v_mul_f32 v166, v166, v76
    v_mul_f32 v167, v167, v76
    v_mul_f32 v168, v168, v76
    v_mul_f32 v169, v169, v76
    v_mul_f32 v170, v170, v76
    v_mul_f32 v171, v171, v76
    v_mul_f32 v172, v172, v76
    v_mul_f32 v173, v173, v76
    v_mul_f32 v174, v174, v76
    v_mul_f32 v175, v175, v76
    v_mul_f32 v60, v60, v76
    v_mul_f32 v61, v61, v76
    v_mul_f32 v62, v62, v76
    v_mul_f32 v63, v63, v76
    s_mov_b32 s64, 0
    s_nop 1
    s_branch L_rescreto
L_poll25:
    ds_read_b32 v4, v3 offset:20
    s_add_u32 s100, s100, 1
    s_cmp_gt_u32 s100, 0x100000
    s_cbranch_scc1 L_end
    s_waitcnt lgkmcnt(0)
    v_cmp_eq_u32 vcc, 0, v4
    s_cbranch_vccnz L_poll25
    s_branch L_pollret25
L_poll26:
    ds_read_b32 v4, v3 offset:24
    s_add_u32 s100, s100, 1
    s_cmp_gt_u32 s100, 0x100000
    s_cbranch_scc1 L_end
    s_waitcnt lgkmcnt(0)
    v_cmp_eq_u32 vcc, 0, v4
    s_cbranch_vccnz L_poll26
    s_branch L_pollret26
L_raree:
    v_mov_b32 v78, v54
    s_nop 1
    v_permlane32_swap_b32 v78, v54
    v_max3_f32 v54, v54, v78, 0
    v_exp_f32 v76, -v54
    v_sub_f32 v208, v208, v54
    v_sub_f32 v209, v209, v54
    v_sub_f32 v210, v210, v54
    v_sub_f32 v211, v211, v54
    v_sub_f32 v212, v212, v54
    v_sub_f32 v213, v213, v54
    v_sub_f32 v214, v214, v54
    v_sub_f32 v215, v215, v54
    v_sub_f32 v216, v216, v54
    v_sub_f32 v217, v217, v54
    v_sub_f32 v218, v218, v54
    v_sub_f32 v219, v219, v54
    v_sub_f32 v220, v220, v54
    v_sub_f32 v221, v221, v54
    v_sub_f32 v222, v222, v54
    v_sub_f32 v223, v223, v54
    v_sub_f32 v224, v224, v54
    v_sub_f32 v225, v225, v54
    v_sub_f32 v226, v226, v54
    v_sub_f32 v227, v227, v54
    v_sub_f32 v228, v228, v54
    v_sub_f32 v229, v229, v54
    v_sub_f32 v230, v230, v54
    v_sub_f32 v231, v231, v54
    v_sub_f32 v232, v232, v54
    v_sub_f32 v233, v233, v54
    v_sub_f32 v234, v234, v54
    v_sub_f32 v235, v235, v54
    v_sub_f32 v236, v236, v54
    v_sub_f32 v237, v237, v54
    v_sub_f32 v238, v238, v54
    v_sub_f32 v239, v239, v54
    v_sub_f32 v240, v240, v54
    v_sub_f32 v241, v241, v54
    v_sub_f32 v242, v242, v54
    v_sub_f32 v243, v243, v54
    v_sub_f32 v244, v244, v54
    v_sub_f32 v245, v245, v54
    v_sub_f32 v246, v246, v54
    v_sub_f32 v247, v247, v54
    v_sub_f32 v248, v248, v54
    v_sub_f32 v249, v249, v54
    v_sub_f32 v250, v250, v54
    v_sub_f32 v251, v251, v54
    v_sub_f32 v252, v252, v54
    v_sub_f32 v253, v253, v54
    v_sub_f32 v254, v254, v54
    v_sub_f32 v255, v255, v54
    s_mov_b32 s64, 1
    s_nop 1
    s_branch L_rarerete
L_resce:
    s_nop 15
    v_mul_f32 v112, v112, v76
    v_mul_f32 v113, v113, v76
    v_mul_f32 v114, v114, v76
    v_mul_f32 v115, v115, v76
    v_mul_f32 v116, v116, v76
    v_mul_f32 v117, v117, v76
    v_mul_f32 v118, v118, v76
    v_mul_f32 v119, v119, v76
    v_mul_f32 v120, v120, v76
    v_mul_f32 v121, v121, v76
    v_mul_f32 v122, v122, v76
    v_mul_f32 v123, v123, v76
    v_mul_f32 v124, v124, v76
    v_mul_f32 v125, v125, v76
    v_mul_f32 v126, v126, v76
    v_mul_f32 v127, v127, v76
    v_mul_f32 v128, v128, v76
    v_mul_f32 v129, v129, v76
    v_mul_f32 v130, v130, v76
    v_mul_f32 v131, v131, v76
    v_mul_f32 v132, v132, v76
    v_mul_f32 v133, v133, v76
    v_mul_f32 v134, v134, v76
    v_mul_f32 v135, v135, v76
    v_mul_f32 v136, v136, v76
    v_mul_f32 v137, v137, v76
    v_mul_f32 v138, v138, v76
    v_mul_f32 v139, v139, v76
    v_mul_f32 v140, v140, v76
    v_mul_f32 v141, v141, v76
    v_mul_f32 v142, v142, v76
    v_mul_f32 v143, v143, v76
    v_mul_f32 v144, v144, v76
    v_mul_f32 v145, v145, v76
    v_mul_f32 v146, v146, v76
    v_mul_f32 v147, v147, v76
    v_mul_f32 v148, v148, v76
    v_mul_f32 v149, v149, v76
    v_mul_f32 v150, v150, v76
    v_mul_f32 v151, v151, v76
    v_mul_f32 v152, v152, v76
    v_mul_f32 v153, v153, v76
    v_mul_f32 v154, v154, v76
    v_mul_f32 v155, v155, v76
    v_mul_f32 v156, v156, v76
    v_mul_f32 v157, v157, v76
    v_mul_f32 v158, v158, v76
    v_mul_f32 v159, v159, v76
    v_mul_f32 v160, v160, v76
    v_mul_f32 v161, v161, v76
    v_mul_f32 v162, v162, v76
    v_mul_f32 v163, v163, v76
    v_mul_f32 v164, v164, v76
    v_mul_f32 v165, v165, v76
    v_mul_f32 v166, v166, v76
    v_mul_f32 v167, v167, v76
    v_mul_f32 v168, v168, v76
    v_mul_f32 v169, v169, v76
    v_mul_f32 v170, v170, v76
    v_mul_f32 v171, v171, v76
    v_mul_f32 v172, v172, v76
    v_mul_f32 v173, v173, v76
    v_mul_f32 v174, v174, v76
    v_mul_f32 v175, v175, v76
    v_mul_f32 v60, v60, v76
    v_mul_f32 v61, v61, v76
    v_mul_f32 v62, v62, v76
    v_mul_f32 v63, v63, v76
    s_mov_b32 s64, 0
    s_nop 1
    s_branch L_rescrete
L_rescf:
    s_nop 15
    v_mul_f32 v112, v112, v76
    v_mul_f32 v113, v113, v76
    v_mul_f32 v114, v114, v76
    v_mul_f32 v115, v115, v76
    v_mul_f32 v116, v116, v76
    v_mul_f32 v117, v117, v76
    v_mul_f32 v118, v118, v76
    v_mul_f32 v119, v119, v76
    v_mul_f32 v120, v120, v76
    v_mul_f32 v121, v121, v76
    v_mul_f32 v122, v122, v76
    v_mul_f32 v123, v123, v76
    v_mul_f32 v124, v124, v76
    v_mul_f32 v125, v125, v76
    v_mul_f32 v126, v126, v76
    v_mul_f32 v127, v127, v76
    v_mul_f32 v128, v128, v76
    v_mul_f32 v129, v129, v76
    v_mul_f32 v130, v130, v76
    v_mul_f32 v131, v131, v76
    v_mul_f32 v132, v132, v76
    v_mul_f32 v133, v133, v76
    v_mul_f32 v134, v134, v76
    v_mul_f32 v135, v135, v76
    v_mul_f32 v136, v136, v76
    v_mul_f32 v137, v137, v76
    v_mul_f32 v138, v138, v76
    v_mul_f32 v139, v139, v76
    v_mul_f32 v140, v140, v76
    v_mul_f32 v141, v141, v76
    v_mul_f32 v142, v142, v76
    v_mul_f32 v143, v143, v76
    v_mul_f32 v144, v144, v76
    v_mul_f32 v145, v145, v76
    v_mul_f32 v146, v146, v76
    v_mul_f32 v147, v147, v76
    v_mul_f32 v148, v148, v76
    v_mul_f32 v149, v149, v76
    v_mul_f32 v150, v150, v76
    v_mul_f32 v151, v151, v76
    v_mul_f32 v152, v152, v76
    v_mul_f32 v153, v153, v76
    v_mul_f32 v154, v154, v76
    v_mul_f32 v155, v155, v76
    v_mul_f32 v156, v156, v76
    v_mul_f32 v157, v157, v76
    v_mul_f32 v158, v158, v76
    v_mul_f32 v159, v159, v76
    v_mul_f32 v160, v160, v76
    v_mul_f32 v161, v161, v76
    v_mul_f32 v162, v162, v76
    v_mul_f32 v163, v163, v76
    v_mul_f32 v164, v164, v76
    v_mul_f32 v165, v165, v76
    v_mul_f32 v166, v166, v76
    v_mul_f32 v167, v167, v76
    v_mul_f32 v168, v168, v76
    v_mul_f32 v169, v169, v76
    v_mul_f32 v170, v170, v76
    v_mul_f32 v171, v171, v76
    v_mul_f32 v172, v172, v76
    v_mul_f32 v173, v173, v76
    v_mul_f32 v174, v174, v76
    v_mul_f32 v175, v175, v76
    v_mul_f32 v60, v60, v76
    v_mul_f32 v61, v61, v76
    v_mul_f32 v62, v62, v76
    v_mul_f32 v63, v63, v76
    s_mov_b32 s64, 0
    s_nop 1
    s_branch L_rescretf
L_poll27:
    ds_read_b32 v84, v101 offset:0
    s_add_u32 s100, s100, 1
    s_cmp_gt_u32 s100, 0x100000
    s_cbranch_scc1 L_end
    s_waitcnt lgkmcnt(0)
    v_cmp_eq_u32 vcc, 0, v84
    s_cbranch_vccnz L_poll27
    s_branch L_pollret27
L_poll28:
    ds_read_b32 v4, v101 offset:8
    s_add_u32 s100, s100, 1
    s_cmp_gt_u32 s100, 0x100000
    s_cbranch_scc1 L_end
    s_waitcnt lgkmcnt(0)
    v_cmp_eq_u32 vcc, 0, v4
    s_cbranch_vccnz L_poll28
    s_branch L_pollret28
L_poll29:
    ds_read_b32 v84, v102 offset:0
    s_add_u32 s100, s100, 1
    s_cmp_gt_u32 s100, 0x100000
    s_cbranch_scc1 L_end
    s_waitcnt lgkmcnt(0)
    v_cmp_eq_u32 vcc, 0, v84
    s_cbranch_vccnz L_poll29
    s_branch L_pollret29
L_poll30:
    ds_read_b32 v4, v102 offset:8
    s_add_u32 s100, s100, 1
    s_cmp_gt_u32 s100, 0x100000
    s_cbranch_scc1 L_end
    s_waitcnt lgkmcnt(0)
    v_cmp_eq_u32 vcc, 0, v4
    s_cbranch_vccnz L_poll30
    s_branch L_pollret30
L_poll31:
    ds_read_b32 v84, v101 offset:16
    s_add_u32 s100, s100, 1
    s_cmp_gt_u32 s100, 0x100000
    s_cbranch_scc1 L_end
    s_waitcnt lgkmcnt(0)
    v_cmp_eq_u32 vcc, 0, v84
    s_cbranch_vccnz L_poll31
    s_branch L_pollret31
L_poll32:
    ds_read_b32 v4, v102 offset:16
    s_add_u32 s100, s100, 1
    s_cmp_gt_u32 s100, 0x100000
    s_cbranch_scc1 L_end
    s_waitcnt lgkmcnt(0)
    v_cmp_eq_u32 vcc, 0, v4
    s_cbranch_vccnz L_poll32
    s_branch L_pollret32
L_poll33:
    ds_read_b32 v84, v101 offset:24
    s_add_u32 s100, s100, 1
    s_cmp_gt_u32 s100, 0x100000
    s_cbranch_scc1 L_end
    s_waitcnt lgkmcnt(0)
    v_cmp_eq_u32 vcc, 0, v84
    s_cbranch_vccnz L_poll33
    s_branch L_pollret33
L_poll34:
    ds_read_b32 v4, v102 offset:24
    s_add_u32 s100, s100, 1
    s_cmp_gt_u32 s100, 0x100000
    s_cbranch_scc1 L_end
    s_waitcnt lgkmcnt(0)
    v_cmp_eq_u32 vcc, 0, v4
    s_cbranch_vccnz L_poll34
    s_branch L_pollret34
L_poll35:
    ds_read_b32 v84, v101 offset:32
    s_add_u32 s100, s100, 1
    s_cmp_gt_u32 s100, 0x100000
    s_cbranch_scc1 L_end
    s_waitcnt lgkmcnt(0)
    v_cmp_eq_u32 vcc, 0, v84
    s_cbranch_vccnz L_poll35
    s_branch L_pollret35
L_poll36:
    ds_read_b32 v4, v102 offset:32
    s_add_u32 s100, s100, 1
    s_cmp_gt_u32 s100, 0x100000
    s_cbranch_scc1 L_end
    s_waitcnt lgkmcnt(0)
    v_cmp_eq_u32 vcc, 0, v4
    s_cbranch_vccnz L_poll36
    s_branch L_pollret36
L_poll37:
    ds_read_b32 v84, v101 offset:40
    s_add_u32 s100, s100, 1
    s_cmp_gt_u32 s100, 0x100000
    s_cbranch_scc1 L_end
    s_waitcnt lgkmcnt(0)
    v_cmp_eq_u32 vcc, 0, v84
    s_cbranch_vccnz L_poll37
    s_branch L_pollret37
L_poll38:
    ds_read_b32 v4, v102 offset:40
    s_add_u32 s100, s100, 1
    s_cmp_gt_u32 s100, 0x100000
    s_cbranch_scc1 L_end
    s_waitcnt lgkmcnt(0)
    v_cmp_eq_u32 vcc, 0, v4
    s_cbranch_vccnz L_poll38
    s_branch L_pollret38
L_poll39:
    ds_read_b32 v84, v101 offset:48
    s_add_u32 s100, s100, 1
    s_cmp_gt_u32 s100, 0x100000
    s_cbranch_scc1 L_end
    s_waitcnt lgkmcnt(0)
    v_cmp_eq_u32 vcc, 0, v84
    s_cbranch_vccnz L_poll39
    s_branch L_pollret39
L_poll40:
    ds_read_b32 v4, v102 offset:48
    s_add_u32 s100, s100, 1
    s_cmp_gt_u32 s100, 0x100000
    s_cbranch_scc1 L_end
    s_waitcnt lgkmcnt(0)
    v_cmp_eq_u32 vcc, 0, v4
    s_cbranch_vccnz L_poll40
    s_branch L_pollret40
L_poll41:
    ds_read_b32 v84, v101 offset:56
    s_add_u32 s100, s100, 1
    s_cmp_gt_u32 s100, 0x100000
    s_cbranch_scc1 L_end
    s_waitcnt lgkmcnt(0)
    v_cmp_eq_u32 vcc, 0, v84
    s_cbranch_vccnz L_poll41
    s_branch L_pollret41
L_poll42:
    ds_read_b32 v4, v102 offset:56
    s_add_u32 s100, s100, 1
    s_cmp_gt_u32 s100, 0x100000
    s_cbranch_scc1 L_end
    s_waitcnt lgkmcnt(0)
    v_cmp_eq_u32 vcc, 0, v4
    s_cbranch_vccnz L_poll42
    s_branch L_pollret42
L_poll43:
    ds_read_b32 v84, v101 offset:64
    s_add_u32 s100, s100, 1
    s_cmp_gt_u32 s100, 0x100000
    s_cbranch_scc1 L_end
    s_waitcnt lgkmcnt(0)
    v_cmp_eq_u32 vcc, 0, v84
    s_cbranch_vccnz L_poll43
    s_branch L_pollret43
L_poll44:
    ds_read_b32 v4, v102 offset:64
    s_add_u32 s100, s100, 1
    s_cmp_gt_u32 s100, 0x100000
    s_cbranch_scc1 L_end
    s_waitcnt lgkmcnt(0)
    v_cmp_eq_u32 vcc, 0, v4
    s_cbranch_vccnz L_poll44
    s_branch L_pollret44
.section .rodata,"a"
.p2align 6
.amdhsa_kernel standalone__gqa_block_cached__near_ridge_kernel
  .amdhsa_next_free_vgpr 256
  .amdhsa_next_free_sgpr 102
  .amdhsa_accum_offset 256
  .amdhsa_group_segment_fixed_size 0
  .amdhsa_kernarg_size 64
  .amdhsa_user_sgpr_count 2
  .amdhsa_user_sgpr_kernarg_segment_ptr 1
  .amdhsa_system_sgpr_workgroup_id_x 1
.end_amdhsa_kernel
```
